```python
import torch

def _softmax(x, axis=-1):
    return torch.softmax(x, dim=axis)
def _gelu(x):
    return torch.nn.functional.gelu(x, approximate="tanh")
def _silu(x):
    return torch.nn.functional.silu(x)
def _sigmoid(x):
    return torch.sigmoid(x)
def _layernorm(x, axis=-1, eps=1e-5):
    m = x.mean(dim=axis, keepdim=True)
    v = x.var(dim=axis, keepdim=True, unbiased=False)
    return (x - m) / torch.sqrt(v + eps)
def _scatter_add(tgt, idx, src, axis=0):
    return tgt.clone().index_add_(axis, idx, src)
def _segment_sum(src, seg, n):
    out = torch.zeros((n,) + src.shape[1:], dtype=src.dtype)
    return out.index_add_(0, seg, src)
def _pad(x, pw):
    flat = tuple(v for pair in reversed(pw) for v in pair)
    return torch.nn.functional.pad(x, flat)

kernel_name = 'gated_mix__sliding_local_dilated__swiglu_ffn__prompt'

def setup_inputs():

    _w = (lambda a: (lambda t: t.to(torch.bfloat16) if t.is_floating_point() else t)(torch.as_tensor(a)))
    def _A_setup():
        B, S, D = 1, 2048, 448
        return {
            "x": _w((lambda *s: torch.randn(*s, dtype=torch.bfloat16) * 0.05)(B, S, D)),
            "wqkv": _w((lambda *s: torch.randn(*s, dtype=torch.bfloat16) * 0.8)(D, 3 * D)),
            "wo": _w((lambda *s: torch.randn(*s, dtype=torch.bfloat16) * 0.05)(D, D)),
        }
    _A_in = _A_setup()

    def _B_setup():
        B, S, D, F = 1, 2048, 448, 1792
        return {
            "x": _w((lambda *s: torch.randn(*s, dtype=torch.bfloat16) * 0.05)(B, S, D)),
            "w_gate": _w((lambda *s: torch.randn(*s, dtype=torch.bfloat16) * 0.2)(D, F)),
            "w_up": _w((lambda *s: torch.randn(*s, dtype=torch.bfloat16) * 0.2)(D, F)),
            "w_down": _w((lambda *s: torch.randn(*s, dtype=torch.bfloat16) * 0.2)(F, D)),
        }
    _B_in = _B_setup()

    return {
        "A_x": _A_in["x"],
        "A_wqkv": _A_in["wqkv"],
        "A_wo": _A_in["wo"],
        "B_x": _B_in["x"],
        "B_w_gate": _B_in["w_gate"],
        "B_w_up": _B_in["w_up"],
        "B_w_down": _B_in["w_down"],
        "gate_w": _w((lambda *s: torch.randn(*s, dtype=torch.bfloat16) * 0.05)(448) * 16.0),
    }

def reference(A_x, A_wqkv, A_wo, B_x, B_w_gate, B_w_up, B_w_down, gate_w):
    def _A_ref(x, wqkv, wo):
        B, S, D = x.shape
        H = 16; Dh = D // H
        W, dil = 8, 2
        qkv = (lambda x, *d: x.permute(*d))((x @ wqkv).reshape(B, S, 3, H, Dh), 2, 0, 3, 1, 4)
        q, k, v = qkv[0], qkv[1], qkv[2]
        scale = Dh ** -0.5
        pos = torch.arange(S)
        off = torch.arange(W) * dil
        idx = pos[:, None] - off[None, :]
        mask = idx >= 0
        idx_c = torch.where(mask, idx, 0).reshape(-1)
        kg = k[:, :, idx_c, :].reshape(B, H, S, W, Dh)
        vg = v[:, :, idx_c, :].reshape(B, H, S, W, Dh)
        logits = torch.einsum("bhsd,bhswd->bhsw", q, kg) * scale
        logits = torch.where(mask[None, None, :, :], logits, -1e9)
        attn = _softmax(logits, axis=-1)
        o = torch.einsum("bhsw,bhswd->bhsd", attn, vg)
        return (lambda x, *d: x.permute(*d))(o, 0, 2, 1, 3).reshape(B, S, D) @ wo

    def _B_ref(x, w_gate, w_up, w_down):
        g = _silu(x @ w_gate)
        u = x @ w_up
        return (g * u) @ w_down

    x = A_x
    g = _sigmoid((x * gate_w).sum(-1, keepdims=True))
    a = _A_ref(x, A_wqkv, A_wo)
    b = _B_ref(x, B_w_gate, B_w_up, B_w_down)
    return g * a + (1 - g) * b
```

```asm
; @launch grid=(256,1,1) block=(256,1,1) lds=163840
.amdgcn_target "amdgcn-amd-amdhsa--gfx950"
.text
.globl gated_mix__sliding_local_dilated__swiglu_ffn__prompt_kernel
.p2align 8
.type gated_mix__sliding_local_dilated__swiglu_ffn__prompt_kernel,@function
gated_mix__sliding_local_dilated__swiglu_ffn__prompt_kernel:
    s_cmp_ge_u32 s2, 8
    s_cbranch_scc1 L_nopf
    s_getpc_b64 s[68:69]
L_pc:
    v_lshlrev_b32 v2, 7, v0
    global_load_dword v10, v2, s[68:69]
L_nopf:
    s_load_dwordx16 s[40:55], s[0:1], 0
    s_load_dwordx4 s[56:59], s[0:1], 64
    s_load_dwordx2 s[60:61], s[0:1], 80
    s_cmp_ge_u32 s2, 256
    s_cbranch_scc1 L_exit
    v_lshrrev_b32 v1, 6, v0
    s_and_b32 s63, s2, 7
    s_lshr_b32 s64, s2, 3
    v_readfirstlane_b32 s62, v1
    v_and_b32 v0, 63, v0
    s_mov_b32 s65, s63
    s_cmp_eq_u32 s64, 0
    s_cbranch_scc1 L_spare
    s_cmp_lt_u32 s64, 9
    s_cbranch_scc1 L_attn
    s_lshr_b32 s67, s63, 2
    s_add_u32 s65, s67, 8
    s_and_b32 s66, s63, 3
    s_cmp_eq_u32 s66, 3
    s_cselect_b32 s66, 10, 9
    s_cmp_lt_u32 s64, s66
    s_cbranch_scc1 L_spare
    s_sub_u32 s65, s64, s66
    s_mul_i32 s66, s63, 23
    s_add_u32 s65, s65, s66
    s_sub_u32 s65, s65, s67
    s_mul_i32 s74, s65, 9363
    s_lshr_b32 s74, s74, 16
    s_mul_i32 s66, s74, 7
    s_sub_u32 s75, s65, s66
    s_mov_b32 s66, s65
    s_addk_i32 s66, -98
    s_mul_i32 s67, s66, 43
    s_lshr_b32 s67, s67, 8
    s_mul_i32 s68, s67, 6
    s_sub_u32 s66, s66, s68
    s_add_u32 s66, s66, 7
    s_cmpk_lt_u32 s65, 98
    s_cselect_b32 s72, s74, s67
    s_cselect_b32 s73, s75, s66
    s_add_u32 s69, s73, s72
    s_and_b32 s69, s69, 3
    v_lshrrev_b32 v14, 3, v0
    v_and_b32 v15, 7, v0
    v_lshrrev_b32 v12, 1, v14
    s_and_b32 s68, s62, 1
    s_lshl_b32 s68, s68, 2
    v_xor_b32 v15, s68, v15
    v_xor_b32 v13, v12, v15
    v_mul_u32_u24 v12, 896, v14
    v_lshl_add_u32 v1, v13, 4, v12
    s_mul_i32 s66, s73, 20
    s_add_u32 s66, s66, s62
    s_mul_i32 s66, s66, 28
    s_add_u32 s66, s66, s69
    s_lshl_b32 s66, s66, 8
    v_add_u32 v1, s66, v1
    s_lshl_b32 s78, s62, 10
    s_bitset1_b32 s78, 16
    s_mov_b32 m0, s78
    s_mov_b32 s6, 1835008
    s_mov_b32 s7, 0x20000
    s_movk_i32 s79, 28672
    s_waitcnt lgkmcnt(0)
    s_mov_b64 s[4:5], s[40:41]
    buffer_load_dwordx4 v1, s[4:7], 0 offen offset:0 lds
    s_addk_i32 m0, 4096
    s_lshl_b32 s80, s79, 1
    v_and_b32 v13, 2, v14
    v_xor_b32 v13, v13, v15
    v_lshlrev_b32 v12, 2, v12
    buffer_load_dwordx4 v1, s[4:7], s79 offen offset:0 lds
    s_addk_i32 m0, 4096
    s_add_u32 s81, s79, s80
    v_lshl_add_u32 v2, v13, 4, v12
    s_lshl_b32 s66, s69, 4
    s_add_u32 s66, s66, s62
    s_mul_i32 s66, s66, s79
    buffer_load_dwordx4 v1, s[4:7], s80 offen offset:0 lds
    s_addk_i32 m0, 4096
    s_lshl_b32 s82, s79, 2
    s_lshl_b32 s67, s72, 8
    s_add_u32 s66, s66, s67
    v_add_u32 v2, s66, v2
    buffer_load_dwordx4 v1, s[4:7], s81 offen offset:0 lds
    s_addk_i32 m0, 4096
    s_mov_b64 s[8:9], s[48:49]
    s_mov_b32 s10, 1605632
    s_mov_b32 s11, s7
    s_lshl_b32 s77, s62, 12
    buffer_load_dwordx4 v1, s[4:7], s82 offen offset:0 lds
    s_mov_b32 m0, s77
    s_sub_u32 s12, s50, 2048
    s_subb_u32 s13, s51, 0
    buffer_load_dwordx4 v2, s[8:11], 0 offen offset:0 lds
    s_add_u32 s14, s10, 2048
    s_mov_b32 s15, s7
    buffer_load_dwordx4 v2, s[12:15], 0 offen offset:2048 lds
    s_mov_b32 s83, 113664
    buffer_load_dwordx4 v2, s[8:11], s83 offen offset:1024 lds
    buffer_load_dwordx4 v2, s[12:15], s83 offen offset:3072 lds
    s_lshl_b32 s69, s69, 1
    s_sub_u32 s90, 6, s69
    s_movk_i32 s93, -768
    s_mov_b32 s99, -1376256
    s_cmp_eq_u32 s90, 0
    s_cselect_b32 s91, s93, 128
    v_add_u32 v1, s91, v1
    s_cmp_eq_u32 s90, 0
    s_cselect_b32 s91, s99, 229376
    v_add_u32 v2, s91, v2
    s_mov_b64 s[24:25], s[60:61]
    s_mov_b32 s26, 16777216
    s_mov_b32 s27, 0x20000
    s_mov_b64 s[16:17], s[52:53]
    s_mov_b32 s18, 1605632
    s_mov_b32 s19, 0x20000
    s_mov_b64 s[20:21], s[44:45]
    s_mov_b32 s22, 401408
    s_mov_b32 s23, 0x20000
    s_mov_b64 s[28:29], s[56:57]
    s_mov_b32 s30, 1835008
    s_mov_b32 s31, 0x20000
    s_mov_b64 s[32:33], s[58:59]
    s_mov_b32 s34, 256
    s_mov_b32 s35, 0x20000
    v_lshrrev_b32 v14, 4, v0
    v_and_b32 v15, 15, v0
    v_lshrrev_b32 v12, 1, v15
    v_xor_b32 v12, v12, v14
    v_lshlrev_b32 v12, 4, v12
    v_lshl_add_u32 v12, v15, 7, v12
    s_lshr_b32 s66, s62, 1
    s_mul_i32 s66, s66, 10240
    s_add_u32 s66, s66, 65536
    v_add_u32 v3, s66, v12
    v_xor_b32 v4, 64, v3
    v_bfe_u32 v12, v0, 2, 2
    v_lshrrev_b32 v13, 1, v12
    v_and_b32 v15, 1, v14
    v_lshlrev_b32 v15, 1, v15
    v_or_b32 v13, v13, v15
    s_and_b32 s66, s62, 1
    s_lshl_b32 s66, s66, 1
    v_xor_b32 v13, s66, v13
    v_lshlrev_b32 v13, 5, v13
    v_lshl_add_u32 v13, v14, 12, v13
    v_lshl_add_u32 v13, v12, 7, v13
    v_and_b32 v15, 3, v0
    v_lshl_add_u32 v5, v15, 3, v13
    v_xor_b32 v6, 32, v5
    s_mul_i32 s39, s74, 5
    v_lshrrev_b32 v196, 3, v0
    v_and_b32 v197, 6, v196
    v_and_b32 v198, 7, v0
    v_xor_b32 v197, v197, v198
    v_mul_u32_u24 v196, 896, v196
    v_lshl_add_u32 v7, v197, 4, v196
    s_lshr_b32 s66, s62, 1
    s_mul_i32 s66, s66, 28
    s_and_b32 s67, s62, 1
    s_add_u32 s69, s66, s67
    s_lshl_b32 s68, s75, 7
    v_add_u32 v7, s68, v7
    s_add_u32 s66, s74, s75
    s_and_b32 s66, s66, 3
    s_sub_u32 s38, 3, s66
    s_lshl_b32 s67, s62, 2
    s_add_u32 s68, s66, s67
    s_mul_i32 s66, s68, 25088
    v_add_u32 v248, s66, v7
    s_add_u32 s66, s68, 56
    s_mul_i32 s66, s66, 130
    s_add_u32 s66, s66, s39
    s_lshl_b32 s66, s66, 10
    s_add_u32 s71, s66, 1048576
    s_mov_b32 s36, -75264
    s_mov_b32 s37, -399360
    s_lshl_b32 s66, s74, 1
    s_add_u32 s66, s66, s75
    s_mul_i32 s67, s66, 9363
    s_lshr_b32 s67, s67, 16
    s_mul_i32 s67, s67, 7
    s_sub_u32 s66, s66, s67
    s_sub_u32 s100, 6, s66
    s_lshl_b32 s66, s66, 2
    s_add_u32 s69, s69, s66
    s_mul_i32 s67, s69, 28672
    v_add_u32 v7, s67, v7
    s_mov_b32 s101, -688128
    s_mov_b32 s3, -3194880
    s_mul_i32 s66, s69, 130
    s_add_u32 s66, s66, s39
    s_lshl_b32 s66, s66, 10
    s_add_u32 s88, s66, 1048576
    s_mov_b32 s84, 6144
    s_mov_b32 s85, 12288
    s_mov_b32 s86, 18432
    s_lshl_b32 s68, s73, 1
    s_lshr_b32 s67, s62, 1
    s_add_u32 s68, s68, s67
    s_lshl_b32 s66, s72, 2
    s_and_b32 s69, s62, 1
    s_add_u32 s66, s66, s69
    s_mul_i32 s66, s66, 130
    s_mul_i32 s67, s68, 5
    s_add_u32 s66, s66, s67
    s_lshl_b32 s66, s66, 10
    s_add_u32 s87, s66, 1048576
    s_lshl_b32 s66, s68, 3
    s_add_u32 s66, s66, s69
    s_cmp_ge_u32 s72, 7
    s_cselect_b32 s67, 2, 0
    s_add_u32 s66, s66, s67
    s_lshl_b32 s66, s66, 7
    v_mov_b32 v10, 2147483648
    v_mov_b32 v12, s66
    v_cmp_eq_u32 vcc, 0, v0
    v_lshlrev_b32 v8, 4, v0
    v_add_u32 v9, 4096, v8
    v_cndmask_b32 v10, v10, v12, vcc
    s_mul_i32 s76, s62, 24576
    s_add_u32 s76, s76, 65536
    s_mov_b32 s89, 0xbfb8aa3b
    v_mov_b32 v11, 1
    v_mov_b32 v15, 0
    s_or_b32 s66, s65, s62
    v_or_b32 v250, s66, v0
    v_lshlrev_b32 v250, 8, v250
    v_bfe_u32 v196, v0, 4, 1
    v_bfe_u32 v197, v0, 2, 2
    v_lshl_add_u32 v196, v196, 2, v197
    v_lshrrev_b32 v197, 5, v0
    v_lshlrev_b32 v197, 10, v197
    v_lshl_add_u32 v197, v196, 7, v197
    v_and_b32 v198, 3, v0
    v_lshl_add_u32 v197, v198, 3, v197
    v_lshrrev_b32 v196, 1, v196
    s_add_u32 s66, s62, 0
    s_and_b32 s66, s66, 3
    v_xor_b32 v198, s66, v196
    v_lshl_add_u32 v198, v198, 5, v197
    v_add_u32 v176, s76, v198
    v_add_u32 v180, s77, v198
    s_add_u32 s66, s62, 1
    s_and_b32 s66, s66, 3
    v_xor_b32 v198, s66, v196
    v_lshl_add_u32 v198, v198, 5, v197
    v_add_u32 v177, s76, v198
    v_add_u32 v181, s77, v198
    s_add_u32 s66, s62, 2
    s_and_b32 s66, s66, 3
    v_xor_b32 v198, s66, v196
    v_lshl_add_u32 v198, v198, 5, v197
    v_add_u32 v178, s76, v198
    v_add_u32 v182, s77, v198
    s_add_u32 s66, s62, 3
    s_and_b32 s66, s66, 3
    v_xor_b32 v198, s66, v196
    v_lshl_add_u32 v198, v198, 5, v197
    v_add_u32 v179, s76, v198
    v_add_u32 v183, s77, v198
    v_lshrrev_b32 v196, 5, v0
    s_add_u32 s67, s39, 4
    s_mul_i32 s66, s39, 13108
    s_lshr_b32 s66, s66, 16
    s_mul_i32 s68, s67, 13108
    s_lshr_b32 s68, s68, 16
    s_sub_u32 s68, s68, s66
    s_lshl_b32 s68, s68, 10
    s_lshl_b32 s66, s66, 3
    s_add_u32 s66, s66, s62
    s_lshl_b32 s66, s66, 7
    v_mul_u32_u24 v197, s68, v196
    v_add_u32 v13, s66, v197
    s_lshr_b32 s66, s39, 3
    s_lshr_b32 s68, s67, 3
    s_min_u32 s68, s68, 15
    s_sub_u32 s68, s68, s66
    s_lshl_b32 s68, s68, 9
    s_lshl_b32 s66, s66, 2
    s_add_u32 s66, s66, s62
    s_add_u32 s66, s66, 208
    s_lshl_b32 s66, s66, 7
    v_mul_u32_u24 v197, s68, v196
    v_add_u32 v187, s66, v197
    s_lshl_b32 s66, s39, 4
    v_and_b32 v196, 15, v0
    v_add_u32 v196, s66, v196
    s_mul_i32 s67, s62, 8704
    s_add_u32 s67, s67, 524288
    v_lshlrev_b32 v188, 2, v196
    v_add_u32 v188, s67, v188
    v_mul_u32_u24 v196, 896, v196
    v_lshrrev_b32 v197, 4, v0
    v_lshl_add_u32 v196, v197, 3, v196
    s_lshl_b32 s67, s75, 7
    s_lshl_b32 s68, s62, 5
    s_add_u32 s67, s67, s68
    v_add_u32 v189, s67, v196
    s_mul_i32 s66, s62, 24576
    s_add_u32 s66, s66, 65536
    v_add_u32 v190, s66, v8
    s_sub_u32 s66, s62, 1
    s_and_b32 s66, s66, 3
    s_mul_i32 s66, s66, 24576
    s_add_u32 s66, s66, 65536
    v_add_u32 v184, s66, v8
    s_sub_u32 s66, s62, 2
    s_and_b32 s66, s66, 3
    s_mul_i32 s66, s66, 24576
    s_add_u32 s66, s66, 70656
    v_add_u32 v185, s66, v8
    s_sub_u32 s66, s62, 3
    s_and_b32 s66, s66, 3
    s_mul_i32 s66, s66, 24576
    s_add_u32 s66, s66, 75776
    v_add_u32 v186, s66, v8
    s_mov_b32 s40, 14336
    s_mov_b32 s41, 28672
    s_mov_b32 s42, 43008
    s_mov_b32 s43, 57344
    s_cmp_ge_u32 s39, 125
    s_cselect_b32 s52, 2147483648, 0
    v_or_b32 v251, s52, v8
    v_or_b32 v252, s52, v9
    s_mov_b32 s48, s89
    s_mov_b32 s49, s89
    s_mov_b32 s50, 1.0
    s_mov_b32 s51, 1.0
    s_add_u32 s66, s77, 147456
    v_add_u32 v249, s66, v8
    ds_write_b128 v249, v[176:179] offset:0
    ds_write_b128 v249, v[180:183] offset:1024
    ds_write_b128 v249, v[184:187] offset:2048
    ds_write_b128 v249, v[188:191] offset:3072
    s_add_u32 m0, s78, 20480
    s_nop 0
    buffer_load_dwordx4 v1, s[4:7], 0 offen offset:0 lds
    s_add_u32 m0, s78, 24576
    s_nop 0
    buffer_load_dwordx4 v1, s[4:7], s79 offen offset:0 lds
    s_add_u32 m0, s78, 28672
    s_nop 0
    buffer_load_dwordx4 v1, s[4:7], s80 offen offset:0 lds
    s_add_u32 m0, s78, 32768
    s_nop 0
    buffer_load_dwordx4 v1, s[4:7], s81 offen offset:0 lds
    s_add_u32 m0, s78, 36864
    s_nop 0
    buffer_load_dwordx4 v1, s[4:7], s82 offen offset:0 lds
    s_cmp_eq_u32 s90, 1
    s_cselect_b32 s91, s93, 128
    v_add_u32 v1, s91, v1
    s_add_u32 m0, s77, 16384
    s_nop 0
    buffer_load_dwordx4 v2, s[8:11], 0 offen offset:0 lds
    buffer_load_dwordx4 v2, s[12:15], 0 offen offset:2048 lds
    buffer_load_dwordx4 v2, s[8:11], s83 offen offset:1024 lds
    buffer_load_dwordx4 v2, s[12:15], s83 offen offset:3072 lds
    s_cmp_eq_u32 s90, 1
    s_cselect_b32 s91, s99, 229376
    v_add_u32 v2, s91, v2
    s_waitcnt vmcnt(11) lgkmcnt(0)
    s_barrier
    ds_read_b64_tr_b16 v[200:201], v5 offset:0
    ds_read_b64_tr_b16 v[202:203], v5 offset:512
    ds_read_b64_tr_b16 v[204:205], v6 offset:0
    ds_read_b64_tr_b16 v[206:207], v6 offset:512
    ds_read_b128 v[176:179], v3 offset:0
    ds_read_b128 v[180:183], v3 offset:2048
    ds_read_b128 v[184:187], v3 offset:4096
    ds_read_b128 v[188:191], v3 offset:6144
    ds_read_b128 v[192:195], v3 offset:8192
    ds_read_b64_tr_b16 v[208:209], v5 offset:2048
    ds_read_b64_tr_b16 v[210:211], v5 offset:2560
    ds_read_b64_tr_b16 v[212:213], v6 offset:2048
    ds_read_b64_tr_b16 v[214:215], v6 offset:2560
    s_waitcnt lgkmcnt(0)
    v_mfma_f32_16x16x32_bf16 v[16:19], v[200:203], v[176:179], 0
    s_add_u32 m0, s78, 40960
    ds_read_b128 v[196:199], v4 offset:0
    v_mfma_f32_16x16x32_bf16 v[20:23], v[200:203], v[180:183], 0
    ds_read_b128 a[0:3], v4 offset:2048
    buffer_load_dwordx4 v1, s[4:7], 0 offen offset:0 lds
    v_mfma_f32_16x16x32_bf16 v[24:27], v[200:203], v[184:187], 0
    s_add_u32 m0, s78, 45056
    ds_read_b128 a[4:7], v4 offset:4096
    v_mfma_f32_16x16x32_bf16 v[28:31], v[200:203], v[188:191], 0
    ds_read_b128 a[8:11], v4 offset:6144
    buffer_load_dwordx4 v1, s[4:7], s79 offen offset:0 lds
    v_mfma_f32_16x16x32_bf16 v[32:35], v[200:203], v[192:195], 0
    ds_read_b128 a[12:15], v4 offset:8192
    v_mfma_f32_16x16x32_bf16 v[36:39], v[204:207], v[176:179], 0
    s_add_u32 m0, s78, 49152
    v_mfma_f32_16x16x32_bf16 v[40:43], v[204:207], v[180:183], 0
    buffer_load_dwordx4 v1, s[4:7], s80 offen offset:0 lds
    v_mfma_f32_16x16x32_bf16 v[44:47], v[204:207], v[184:187], 0
    s_waitcnt vmcnt(12)
    s_barrier
    v_mfma_f32_16x16x32_bf16 v[48:51], v[204:207], v[188:191], 0
    s_add_u32 m0, s78, 53248
    ds_read_b64_tr_b16 v[216:217], v5 offset:1024
    v_mfma_f32_16x16x32_bf16 v[52:55], v[204:207], v[192:195], 0
    ds_read_b64_tr_b16 v[218:219], v5 offset:1536
    buffer_load_dwordx4 v1, s[4:7], s81 offen offset:0 lds
    v_mfma_f32_16x16x32_bf16 v[56:59], v[208:211], v[176:179], 0
    ds_read_b64_tr_b16 v[220:221], v6 offset:1024
    v_mfma_f32_16x16x32_bf16 v[60:63], v[208:211], v[180:183], 0
    s_add_u32 m0, s78, 57344
    ds_read_b64_tr_b16 v[222:223], v6 offset:1536
    v_mfma_f32_16x16x32_bf16 v[64:67], v[208:211], v[184:187], 0
    s_cmp_eq_u32 s90, 2
    s_cselect_b32 s91, s93, 128
    ds_read_b64_tr_b16 v[224:225], v5 offset:3072
    v_mfma_f32_16x16x32_bf16 v[68:71], v[208:211], v[188:191], 0
    buffer_load_dwordx4 v1, s[4:7], s82 offen offset:0 lds
    ds_read_b64_tr_b16 v[226:227], v5 offset:3584
    v_mfma_f32_16x16x32_bf16 v[72:75], v[208:211], v[192:195], 0
    ds_read_b64_tr_b16 v[228:229], v6 offset:3072
    v_add_u32 v1, s91, v1
    v_mfma_f32_16x16x32_bf16 v[76:79], v[212:215], v[176:179], 0
    ds_read_b64_tr_b16 v[230:231], v6 offset:3584
    v_mfma_f32_16x16x32_bf16 v[80:83], v[212:215], v[180:183], 0
    v_mfma_f32_16x16x32_bf16 v[84:87], v[212:215], v[184:187], 0
    v_mfma_f32_16x16x32_bf16 v[88:91], v[212:215], v[188:191], 0
    v_mfma_f32_16x16x32_bf16 v[92:95], v[212:215], v[192:195], 0
    s_waitcnt vmcnt(5) lgkmcnt(0)
    s_barrier
    v_mfma_f32_16x16x32_bf16 v[16:19], v[216:219], v[196:199], v[16:19]
    s_add_u32 m0, s77, 32768
    ds_read_b64_tr_b16 v[200:201], v5 offset:16384
    ds_read_b64_tr_b16 v[202:203], v5 offset:16896
    v_mfma_f32_16x16x32_bf16 v[20:23], v[216:219], a[0:3], v[20:23]
    buffer_load_dwordx4 v2, s[8:11], 0 offen offset:0 lds
    ds_read_b64_tr_b16 v[204:205], v5 offset:17408
    v_mfma_f32_16x16x32_bf16 v[24:27], v[216:219], a[4:7], v[24:27]
    ds_read_b64_tr_b16 v[206:207], v5 offset:17920
    v_mfma_f32_16x16x32_bf16 v[28:31], v[216:219], a[8:11], v[28:31]
    ds_read_b128 a[16:19], v3 offset:20480
    v_mfma_f32_16x16x32_bf16 v[32:35], v[216:219], a[12:15], v[32:35]
    ds_read_b128 a[20:23], v3 offset:22528
    buffer_load_dwordx4 v2, s[12:15], 0 offen offset:2048 lds
    v_mfma_f32_16x16x32_bf16 v[36:39], v[220:223], v[196:199], v[36:39]
    ds_read_b128 a[24:27], v3 offset:24576
    v_mfma_f32_16x16x32_bf16 v[40:43], v[220:223], a[0:3], v[40:43]
    ds_read_b128 a[28:31], v3 offset:26624
    v_mfma_f32_16x16x32_bf16 v[44:47], v[220:223], a[4:7], v[44:47]
    ds_read_b128 a[32:35], v3 offset:28672
    v_mfma_f32_16x16x32_bf16 v[48:51], v[220:223], a[8:11], v[48:51]
    ds_read_b128 a[36:39], v4 offset:20480
    buffer_load_dwordx4 v2, s[8:11], s83 offen offset:1024 lds
    v_mfma_f32_16x16x32_bf16 v[52:55], v[220:223], a[12:15], v[52:55]
    ds_read_b128 a[40:43], v4 offset:22528
    v_mfma_f32_16x16x32_bf16 v[56:59], v[224:227], v[196:199], v[56:59]
    ds_read_b128 a[44:47], v4 offset:24576
    v_mfma_f32_16x16x32_bf16 v[60:63], v[224:227], a[0:3], v[60:63]
    s_cmp_eq_u32 s90, 2
    s_cselect_b32 s91, s99, 229376
    ds_read_b128 a[48:51], v4 offset:26624
    v_mfma_f32_16x16x32_bf16 v[64:67], v[224:227], a[4:7], v[64:67]
    ds_read_b128 a[52:55], v4 offset:28672
    buffer_load_dwordx4 v2, s[12:15], s83 offen offset:3072 lds
    v_mfma_f32_16x16x32_bf16 v[68:71], v[224:227], a[8:11], v[68:71]
    ds_read_b64_tr_b16 v[208:209], v5 offset:18432
    v_add_u32 v2, s91, v2
    v_mfma_f32_16x16x32_bf16 v[72:75], v[224:227], a[12:15], v[72:75]
    ds_read_b64_tr_b16 v[210:211], v5 offset:18944
    v_mfma_f32_16x16x32_bf16 v[76:79], v[228:231], v[196:199], v[76:79]
    s_add_u32 m0, s78, 61440
    ds_read_b64_tr_b16 v[212:213], v5 offset:19456
    v_mfma_f32_16x16x32_bf16 v[80:83], v[228:231], a[0:3], v[80:83]
    ds_read_b64_tr_b16 v[214:215], v5 offset:19968
    buffer_load_dwordx4 v1, s[4:7], 0 offen offset:0 lds
    v_mfma_f32_16x16x32_bf16 v[84:87], v[228:231], a[4:7], v[84:87]
    v_mfma_f32_16x16x32_bf16 v[88:91], v[228:231], a[8:11], v[88:91]
    v_mfma_f32_16x16x32_bf16 v[92:95], v[228:231], a[12:15], v[92:95]
    s_waitcnt lgkmcnt(0)
    v_mfma_f32_16x16x32_bf16 v[16:19], v[200:203], a[16:19], v[16:19]
    s_add_u32 m0, s78, 65536
    ds_read_b64_tr_b16 v[216:217], v6 offset:16384
    v_mfma_f32_16x16x32_bf16 v[16:19], v[204:207], a[36:39], v[16:19]
    ds_read_b64_tr_b16 v[218:219], v6 offset:16896
    buffer_load_dwordx4 v1, s[4:7], s79 offen offset:0 lds
    v_mfma_f32_16x16x32_bf16 v[20:23], v[200:203], a[20:23], v[20:23]
    ds_read_b64_tr_b16 v[220:221], v6 offset:17408
    v_mfma_f32_16x16x32_bf16 v[20:23], v[204:207], a[40:43], v[20:23]
    s_add_u32 m0, s78, 69632
    ds_read_b64_tr_b16 v[222:223], v6 offset:17920
    v_mfma_f32_16x16x32_bf16 v[24:27], v[200:203], a[24:27], v[24:27]
    ds_read_b64_tr_b16 v[224:225], v6 offset:18432
    buffer_load_dwordx4 v1, s[4:7], s80 offen offset:0 lds
    v_mfma_f32_16x16x32_bf16 v[24:27], v[204:207], a[44:47], v[24:27]
    ds_read_b64_tr_b16 v[226:227], v6 offset:18944
    v_mfma_f32_16x16x32_bf16 v[28:31], v[200:203], a[28:31], v[28:31]
    ds_read_b64_tr_b16 v[228:229], v6 offset:19456
    v_mfma_f32_16x16x32_bf16 v[28:31], v[204:207], a[48:51], v[28:31]
    s_add_u32 m0, s78, 73728
    ds_read_b64_tr_b16 v[230:231], v6 offset:19968
    v_mfma_f32_16x16x32_bf16 v[32:35], v[200:203], a[32:35], v[32:35]
    buffer_load_dwordx4 v1, s[4:7], s81 offen offset:0 lds
    v_mfma_f32_16x16x32_bf16 v[32:35], v[204:207], a[52:55], v[32:35]
    v_mfma_f32_16x16x32_bf16 v[56:59], v[208:211], a[16:19], v[56:59]
    v_mfma_f32_16x16x32_bf16 v[56:59], v[212:215], a[36:39], v[56:59]
    s_add_u32 m0, s78, 77824
    s_cmp_eq_u32 s90, 3
    s_cselect_b32 s91, s93, 128
    v_mfma_f32_16x16x32_bf16 v[60:63], v[208:211], a[20:23], v[60:63]
    buffer_load_dwordx4 v1, s[4:7], s82 offen offset:0 lds
    v_mfma_f32_16x16x32_bf16 v[60:63], v[212:215], a[40:43], v[60:63]
    v_add_u32 v1, s91, v1
    v_mfma_f32_16x16x32_bf16 v[64:67], v[208:211], a[24:27], v[64:67]
    v_mfma_f32_16x16x32_bf16 v[64:67], v[212:215], a[44:47], v[64:67]
    s_add_u32 m0, s77, 49152
    v_mfma_f32_16x16x32_bf16 v[68:71], v[208:211], a[28:31], v[68:71]
    buffer_load_dwordx4 v2, s[8:11], 0 offen offset:0 lds
    v_mfma_f32_16x16x32_bf16 v[68:71], v[212:215], a[48:51], v[68:71]
    v_mfma_f32_16x16x32_bf16 v[72:75], v[208:211], a[32:35], v[72:75]
    v_mfma_f32_16x16x32_bf16 v[72:75], v[212:215], a[52:55], v[72:75]
    s_waitcnt vmcnt(6) lgkmcnt(0)
    s_barrier
    v_mfma_f32_16x16x32_bf16 v[36:39], v[216:219], a[16:19], v[36:39]
    ds_read_b64_tr_b16 v[200:201], v5 offset:32768
    ds_read_b64_tr_b16 v[202:203], v5 offset:33280
    v_mfma_f32_16x16x32_bf16 v[36:39], v[220:223], a[36:39], v[36:39]
    buffer_load_dwordx4 v2, s[12:15], 0 offen offset:2048 lds
    ds_read_b64_tr_b16 v[204:205], v5 offset:33792
    v_mfma_f32_16x16x32_bf16 v[40:43], v[216:219], a[20:23], v[40:43]
    ds_read_b64_tr_b16 v[206:207], v5 offset:34304
    v_mfma_f32_16x16x32_bf16 v[40:43], v[220:223], a[40:43], v[40:43]
    ds_read_b128 a[56:59], v3 offset:40960
    v_mfma_f32_16x16x32_bf16 v[44:47], v[216:219], a[24:27], v[44:47]
    ds_read_b128 a[60:63], v3 offset:43008
    buffer_load_dwordx4 v2, s[8:11], s83 offen offset:1024 lds
    v_mfma_f32_16x16x32_bf16 v[44:47], v[220:223], a[44:47], v[44:47]
    ds_read_b128 a[64:67], v3 offset:45056
    v_mfma_f32_16x16x32_bf16 v[48:51], v[216:219], a[28:31], v[48:51]
    ds_read_b128 a[68:71], v3 offset:47104
    v_mfma_f32_16x16x32_bf16 v[48:51], v[220:223], a[48:51], v[48:51]
    s_cmp_eq_u32 s90, 3
    s_cselect_b32 s91, s99, 229376
    ds_read_b128 a[72:75], v3 offset:49152
    v_mfma_f32_16x16x32_bf16 v[52:55], v[216:219], a[32:35], v[52:55]
    ds_read_b128 a[76:79], v4 offset:40960
    buffer_load_dwordx4 v2, s[12:15], s83 offen offset:3072 lds
    v_mfma_f32_16x16x32_bf16 v[52:55], v[220:223], a[52:55], v[52:55]
    ds_read_b128 a[80:83], v4 offset:43008
    v_add_u32 v2, s91, v2
    v_mfma_f32_16x16x32_bf16 v[76:79], v[224:227], a[16:19], v[76:79]
    ds_read_b128 a[84:87], v4 offset:45056
    v_mfma_f32_16x16x32_bf16 v[76:79], v[228:231], a[36:39], v[76:79]
    s_add_u32 m0, s78, 0
    ds_read_b128 a[88:91], v4 offset:47104
    v_mfma_f32_16x16x32_bf16 v[80:83], v[224:227], a[20:23], v[80:83]
    ds_read_b128 a[92:95], v4 offset:49152
    buffer_load_dwordx4 v1, s[4:7], 0 offen offset:0 lds
    v_mfma_f32_16x16x32_bf16 v[80:83], v[228:231], a[40:43], v[80:83]
    ds_read_b64_tr_b16 v[208:209], v5 offset:34816
    v_mfma_f32_16x16x32_bf16 v[84:87], v[224:227], a[24:27], v[84:87]
    ds_read_b64_tr_b16 v[210:211], v5 offset:35328
    v_mfma_f32_16x16x32_bf16 v[84:87], v[228:231], a[44:47], v[84:87]
    s_add_u32 m0, s78, 4096
    ds_read_b64_tr_b16 v[212:213], v5 offset:35840
    v_mfma_f32_16x16x32_bf16 v[88:91], v[224:227], a[28:31], v[88:91]
    ds_read_b64_tr_b16 v[214:215], v5 offset:36352
    buffer_load_dwordx4 v1, s[4:7], s79 offen offset:0 lds
    v_mfma_f32_16x16x32_bf16 v[88:91], v[228:231], a[48:51], v[88:91]
    v_mfma_f32_16x16x32_bf16 v[92:95], v[224:227], a[32:35], v[92:95]
    v_mfma_f32_16x16x32_bf16 v[92:95], v[228:231], a[52:55], v[92:95]
    s_waitcnt lgkmcnt(0)
    v_mfma_f32_16x16x32_bf16 v[16:19], v[200:203], a[56:59], v[16:19]
    s_add_u32 m0, s78, 8192
    ds_read_b64_tr_b16 v[216:217], v6 offset:32768
    v_mfma_f32_16x16x32_bf16 v[16:19], v[204:207], a[76:79], v[16:19]
    ds_read_b64_tr_b16 v[218:219], v6 offset:33280
    buffer_load_dwordx4 v1, s[4:7], s80 offen offset:0 lds
    v_mfma_f32_16x16x32_bf16 v[20:23], v[200:203], a[60:63], v[20:23]
    ds_read_b64_tr_b16 v[220:221], v6 offset:33792
    v_mfma_f32_16x16x32_bf16 v[20:23], v[204:207], a[80:83], v[20:23]
    s_add_u32 m0, s78, 12288
    ds_read_b64_tr_b16 v[222:223], v6 offset:34304
    v_mfma_f32_16x16x32_bf16 v[24:27], v[200:203], a[64:67], v[24:27]
    ds_read_b64_tr_b16 v[224:225], v6 offset:34816
    buffer_load_dwordx4 v1, s[4:7], s81 offen offset:0 lds
    v_mfma_f32_16x16x32_bf16 v[24:27], v[204:207], a[84:87], v[24:27]
    ds_read_b64_tr_b16 v[226:227], v6 offset:35328
    v_mfma_f32_16x16x32_bf16 v[28:31], v[200:203], a[68:71], v[28:31]
    ds_read_b64_tr_b16 v[228:229], v6 offset:35840
    v_mfma_f32_16x16x32_bf16 v[28:31], v[204:207], a[88:91], v[28:31]
    s_add_u32 m0, s78, 16384
    ds_read_b64_tr_b16 v[230:231], v6 offset:36352
    v_mfma_f32_16x16x32_bf16 v[32:35], v[200:203], a[72:75], v[32:35]
    s_cmp_eq_u32 s90, 4
    s_cselect_b32 s91, s93, 128
    buffer_load_dwordx4 v1, s[4:7], s82 offen offset:0 lds
    v_mfma_f32_16x16x32_bf16 v[32:35], v[204:207], a[92:95], v[32:35]
    v_add_u32 v1, s91, v1
    v_mfma_f32_16x16x32_bf16 v[56:59], v[208:211], a[56:59], v[56:59]
    v_mfma_f32_16x16x32_bf16 v[56:59], v[212:215], a[76:79], v[56:59]
    s_add_u32 m0, s77, 0
    v_mfma_f32_16x16x32_bf16 v[60:63], v[208:211], a[60:63], v[60:63]
    buffer_load_dwordx4 v2, s[8:11], 0 offen offset:0 lds
    v_mfma_f32_16x16x32_bf16 v[60:63], v[212:215], a[80:83], v[60:63]
    v_mfma_f32_16x16x32_bf16 v[64:67], v[208:211], a[64:67], v[64:67]
    v_mfma_f32_16x16x32_bf16 v[64:67], v[212:215], a[84:87], v[64:67]
    v_mfma_f32_16x16x32_bf16 v[68:71], v[208:211], a[68:71], v[68:71]
    buffer_load_dwordx4 v2, s[12:15], 0 offen offset:2048 lds
    v_mfma_f32_16x16x32_bf16 v[68:71], v[212:215], a[88:91], v[68:71]
    v_mfma_f32_16x16x32_bf16 v[72:75], v[208:211], a[72:75], v[72:75]
    v_mfma_f32_16x16x32_bf16 v[72:75], v[212:215], a[92:95], v[72:75]
    s_waitcnt vmcnt(7) lgkmcnt(0)
    s_barrier
    v_mfma_f32_16x16x32_bf16 v[36:39], v[216:219], a[56:59], v[36:39]
    ds_read_b64_tr_b16 v[200:201], v5 offset:49152
    ds_read_b64_tr_b16 v[202:203], v5 offset:49664
    v_mfma_f32_16x16x32_bf16 v[36:39], v[220:223], a[76:79], v[36:39]
    buffer_load_dwordx4 v2, s[8:11], s83 offen offset:1024 lds
    ds_read_b64_tr_b16 v[204:205], v5 offset:50176
    v_mfma_f32_16x16x32_bf16 v[40:43], v[216:219], a[60:63], v[40:43]
    ds_read_b64_tr_b16 v[206:207], v5 offset:50688
    v_add_u32 v3, 61440, v3
    v_mfma_f32_16x16x32_bf16 v[40:43], v[220:223], a[80:83], v[40:43]
    s_cmp_eq_u32 s90, 4
    s_cselect_b32 s91, s99, 229376
    ds_read_b128 a[96:99], v3 offset:0
    v_mfma_f32_16x16x32_bf16 v[44:47], v[216:219], a[64:67], v[44:47]
    ds_read_b128 a[100:103], v3 offset:2048
    buffer_load_dwordx4 v2, s[12:15], s83 offen offset:3072 lds
    v_mfma_f32_16x16x32_bf16 v[44:47], v[220:223], a[84:87], v[44:47]
    ds_read_b128 a[104:107], v3 offset:4096
    v_add_u32 v2, s91, v2
    v_mfma_f32_16x16x32_bf16 v[48:51], v[216:219], a[68:71], v[48:51]
    ds_read_b128 a[108:111], v3 offset:6144
    v_add_u32 v4, 61440, v4
    v_mfma_f32_16x16x32_bf16 v[48:51], v[220:223], a[88:91], v[48:51]
    s_add_u32 m0, s78, 20480
    ds_read_b128 a[112:115], v3 offset:8192
    v_subrev_u32 v3, 61440, v3
    v_mfma_f32_16x16x32_bf16 v[52:55], v[216:219], a[72:75], v[52:55]
    ds_read_b128 a[116:119], v4 offset:0
    buffer_load_dwordx4 v1, s[4:7], 0 offen offset:0 lds
    v_mfma_f32_16x16x32_bf16 v[52:55], v[220:223], a[92:95], v[52:55]
    ds_read_b128 a[120:123], v4 offset:2048
    v_mfma_f32_16x16x32_bf16 v[76:79], v[224:227], a[56:59], v[76:79]
    ds_read_b128 a[124:127], v4 offset:4096
    v_mfma_f32_16x16x32_bf16 v[76:79], v[228:231], a[76:79], v[76:79]
    s_add_u32 m0, s78, 24576
    ds_read_b128 a[128:131], v4 offset:6144
    v_mfma_f32_16x16x32_bf16 v[80:83], v[224:227], a[60:63], v[80:83]
    ds_read_b128 a[132:135], v4 offset:8192
    v_subrev_u32 v4, 61440, v4
    v_mfma_f32_16x16x32_bf16 v[80:83], v[228:231], a[80:83], v[80:83]
    ds_read_b64_tr_b16 v[208:209], v5 offset:51200
    buffer_load_dwordx4 v1, s[4:7], s79 offen offset:0 lds
    v_mfma_f32_16x16x32_bf16 v[84:87], v[224:227], a[64:67], v[84:87]
    ds_read_b64_tr_b16 v[210:211], v5 offset:51712
    v_mfma_f32_16x16x32_bf16 v[84:87], v[228:231], a[84:87], v[84:87]
    s_add_u32 m0, s78, 28672
    ds_read_b64_tr_b16 v[212:213], v5 offset:52224
    v_mfma_f32_16x16x32_bf16 v[88:91], v[224:227], a[68:71], v[88:91]
    ds_read_b64_tr_b16 v[214:215], v5 offset:52736
    buffer_load_dwordx4 v1, s[4:7], s80 offen offset:0 lds
    v_mfma_f32_16x16x32_bf16 v[88:91], v[228:231], a[88:91], v[88:91]
    v_mfma_f32_16x16x32_bf16 v[92:95], v[224:227], a[72:75], v[92:95]
    v_mfma_f32_16x16x32_bf16 v[92:95], v[228:231], a[92:95], v[92:95]
    s_waitcnt lgkmcnt(0)
    buffer_store_dword v11, v250, s[32:35], 0 offen offset:4 sc1
    v_mfma_f32_16x16x32_bf16 v[16:19], v[200:203], a[96:99], v[16:19]
    s_add_u32 m0, s78, 32768
    ds_read_b64_tr_b16 v[216:217], v6 offset:49152
    v_mfma_f32_16x16x32_bf16 v[16:19], v[204:207], a[116:119], v[16:19]
    ds_read_b64_tr_b16 v[218:219], v6 offset:49664
    buffer_load_dwordx4 v1, s[4:7], s81 offen offset:0 lds
    v_mfma_f32_16x16x32_bf16 v[20:23], v[200:203], a[100:103], v[20:23]
    ds_read_b64_tr_b16 v[220:221], v6 offset:50176
    v_mfma_f32_16x16x32_bf16 v[20:23], v[204:207], a[120:123], v[20:23]
    s_add_u32 m0, s78, 36864
    ds_read_b64_tr_b16 v[222:223], v6 offset:50688
    v_mfma_f32_16x16x32_bf16 v[24:27], v[200:203], a[104:107], v[24:27]
    s_cmp_eq_u32 s90, 5
    s_cselect_b32 s91, s93, 128
    ds_read_b64_tr_b16 v[224:225], v6 offset:51200
    v_mfma_f32_16x16x32_bf16 v[24:27], v[204:207], a[124:127], v[24:27]
    buffer_load_dwordx4 v1, s[4:7], s82 offen offset:0 lds
    ds_read_b64_tr_b16 v[226:227], v6 offset:51712
    v_mfma_f32_16x16x32_bf16 v[28:31], v[200:203], a[108:111], v[28:31]
    ds_read_b64_tr_b16 v[228:229], v6 offset:52224
    v_add_u32 v1, s91, v1
    v_mfma_f32_16x16x32_bf16 v[28:31], v[204:207], a[128:131], v[28:31]
    s_add_u32 m0, s77, 16384
    ds_read_b64_tr_b16 v[230:231], v6 offset:52736
    v_mfma_f32_16x16x32_bf16 v[32:35], v[200:203], a[112:115], v[32:35]
    buffer_load_dwordx4 v2, s[8:11], 0 offen offset:0 lds
    v_mfma_f32_16x16x32_bf16 v[32:35], v[204:207], a[132:135], v[32:35]
    v_mfma_f32_16x16x32_bf16 v[56:59], v[208:211], a[96:99], v[56:59]
    v_mfma_f32_16x16x32_bf16 v[56:59], v[212:215], a[116:119], v[56:59]
    v_mfma_f32_16x16x32_bf16 v[60:63], v[208:211], a[100:103], v[60:63]
    buffer_load_dwordx4 v2, s[12:15], 0 offen offset:2048 lds
    v_mfma_f32_16x16x32_bf16 v[60:63], v[212:215], a[120:123], v[60:63]
    v_mfma_f32_16x16x32_bf16 v[64:67], v[208:211], a[104:107], v[64:67]
    v_mfma_f32_16x16x32_bf16 v[64:67], v[212:215], a[124:127], v[64:67]
    v_mfma_f32_16x16x32_bf16 v[68:71], v[208:211], a[108:111], v[68:71]
    buffer_load_dwordx4 v2, s[8:11], s83 offen offset:1024 lds
    v_mfma_f32_16x16x32_bf16 v[68:71], v[212:215], a[128:131], v[68:71]
    v_mfma_f32_16x16x32_bf16 v[72:75], v[208:211], a[112:115], v[72:75]
    v_mfma_f32_16x16x32_bf16 v[72:75], v[212:215], a[132:135], v[72:75]
    s_waitcnt vmcnt(9) lgkmcnt(0)
    s_barrier
    v_mfma_f32_16x16x32_bf16 v[36:39], v[216:219], a[96:99], v[36:39]
    s_cmp_eq_u32 s90, 5
    s_cselect_b32 s91, s99, 229376
    ds_read_b64_tr_b16 v[200:201], v5 offset:0
    ds_read_b64_tr_b16 v[202:203], v5 offset:512
    v_mfma_f32_16x16x32_bf16 v[36:39], v[220:223], a[116:119], v[36:39]
    buffer_load_dwordx4 v2, s[12:15], s83 offen offset:3072 lds
    ds_read_b64_tr_b16 v[204:205], v5 offset:1024
    v_mfma_f32_16x16x32_bf16 v[40:43], v[216:219], a[100:103], v[40:43]
    ds_read_b64_tr_b16 v[206:207], v5 offset:1536
    v_add_u32 v2, s91, v2
    v_mfma_f32_16x16x32_bf16 v[40:43], v[220:223], a[120:123], v[40:43]
    s_add_u32 m0, s78, 40960
    ds_read_b128 a[136:139], v3 offset:0
    v_mfma_f32_16x16x32_bf16 v[44:47], v[216:219], a[104:107], v[44:47]
    ds_read_b128 a[140:143], v3 offset:2048
    buffer_load_dwordx4 v1, s[4:7], 0 offen offset:0 lds
    v_mfma_f32_16x16x32_bf16 v[44:47], v[220:223], a[124:127], v[44:47]
    ds_read_b128 a[144:147], v3 offset:4096
    v_mfma_f32_16x16x32_bf16 v[48:51], v[216:219], a[108:111], v[48:51]
    ds_read_b128 a[148:151], v3 offset:6144
    v_mfma_f32_16x16x32_bf16 v[48:51], v[220:223], a[128:131], v[48:51]
    s_add_u32 m0, s78, 45056
    ds_read_b128 a[152:155], v3 offset:8192
    v_mfma_f32_16x16x32_bf16 v[52:55], v[216:219], a[112:115], v[52:55]
    ds_read_b128 a[156:159], v4 offset:0
    buffer_load_dwordx4 v1, s[4:7], s79 offen offset:0 lds
    v_mfma_f32_16x16x32_bf16 v[52:55], v[220:223], a[132:135], v[52:55]
    ds_read_b128 a[160:163], v4 offset:2048
    v_mfma_f32_16x16x32_bf16 v[76:79], v[224:227], a[96:99], v[76:79]
    ds_read_b128 a[164:167], v4 offset:4096
    v_mfma_f32_16x16x32_bf16 v[76:79], v[228:231], a[116:119], v[76:79]
    s_add_u32 m0, s78, 49152
    ds_read_b128 a[168:171], v4 offset:6144
    v_mfma_f32_16x16x32_bf16 v[80:83], v[224:227], a[100:103], v[80:83]
    ds_read_b128 a[172:175], v4 offset:8192
    buffer_load_dwordx4 v1, s[4:7], s80 offen offset:0 lds
    v_mfma_f32_16x16x32_bf16 v[80:83], v[228:231], a[120:123], v[80:83]
    ds_read_b64_tr_b16 v[208:209], v5 offset:2048
    v_mfma_f32_16x16x32_bf16 v[84:87], v[224:227], a[104:107], v[84:87]
    ds_read_b64_tr_b16 v[210:211], v5 offset:2560
    v_mfma_f32_16x16x32_bf16 v[84:87], v[228:231], a[124:127], v[84:87]
    s_add_u32 m0, s78, 53248
    ds_read_b64_tr_b16 v[212:213], v5 offset:3072
    v_mfma_f32_16x16x32_bf16 v[88:91], v[224:227], a[108:111], v[88:91]
    ds_read_b64_tr_b16 v[214:215], v5 offset:3584
    buffer_load_dwordx4 v1, s[4:7], s81 offen offset:0 lds
    v_mfma_f32_16x16x32_bf16 v[88:91], v[228:231], a[128:131], v[88:91]
    v_mfma_f32_16x16x32_bf16 v[92:95], v[224:227], a[112:115], v[92:95]
    v_mfma_f32_16x16x32_bf16 v[92:95], v[228:231], a[132:135], v[92:95]
    s_waitcnt lgkmcnt(0)
    v_mfma_f32_16x16x32_bf16 v[16:19], v[200:203], a[136:139], v[16:19]
    s_add_u32 m0, s78, 57344
    ds_read_b64_tr_b16 v[216:217], v6 offset:0
    v_mfma_f32_16x16x32_bf16 v[16:19], v[204:207], a[156:159], v[16:19]
    s_cmp_eq_u32 s90, 6
    s_cselect_b32 s91, s93, 128
    ds_read_b64_tr_b16 v[218:219], v6 offset:512
    v_mfma_f32_16x16x32_bf16 v[20:23], v[200:203], a[140:143], v[20:23]
    buffer_load_dwordx4 v1, s[4:7], s82 offen offset:0 lds
    ds_read_b64_tr_b16 v[220:221], v6 offset:1024
    v_mfma_f32_16x16x32_bf16 v[20:23], v[204:207], a[160:163], v[20:23]
    s_add_u32 m0, s77, 32768
    ds_read_b64_tr_b16 v[222:223], v6 offset:1536
    v_add_u32 v1, s91, v1
    v_mfma_f32_16x16x32_bf16 v[24:27], v[200:203], a[144:147], v[24:27]
    ds_read_b64_tr_b16 v[224:225], v6 offset:2048
    buffer_load_dwordx4 v2, s[8:11], 0 offen offset:0 lds
    v_mfma_f32_16x16x32_bf16 v[24:27], v[204:207], a[164:167], v[24:27]
    ds_read_b64_tr_b16 v[226:227], v6 offset:2560
    v_mfma_f32_16x16x32_bf16 v[28:31], v[200:203], a[148:151], v[28:31]
    ds_read_b64_tr_b16 v[228:229], v6 offset:3072
    v_mfma_f32_16x16x32_bf16 v[28:31], v[204:207], a[168:171], v[28:31]
    ds_read_b64_tr_b16 v[230:231], v6 offset:3584
    v_mfma_f32_16x16x32_bf16 v[32:35], v[200:203], a[152:155], v[32:35]
    buffer_load_dwordx4 v2, s[12:15], 0 offen offset:2048 lds
    v_mfma_f32_16x16x32_bf16 v[32:35], v[204:207], a[172:175], v[32:35]
    v_mfma_f32_16x16x32_bf16 v[56:59], v[208:211], a[136:139], v[56:59]
    v_mfma_f32_16x16x32_bf16 v[56:59], v[212:215], a[156:159], v[56:59]
    v_mfma_f32_16x16x32_bf16 v[60:63], v[208:211], a[140:143], v[60:63]
    buffer_load_dwordx4 v2, s[8:11], s83 offen offset:1024 lds
    v_mfma_f32_16x16x32_bf16 v[60:63], v[212:215], a[160:163], v[60:63]
    v_mfma_f32_16x16x32_bf16 v[64:67], v[208:211], a[144:147], v[64:67]
    v_mfma_f32_16x16x32_bf16 v[64:67], v[212:215], a[164:167], v[64:67]
    s_cmp_eq_u32 s90, 6
    s_cselect_b32 s91, s99, 229376
    v_mfma_f32_16x16x32_bf16 v[68:71], v[208:211], a[148:151], v[68:71]
    buffer_load_dwordx4 v2, s[12:15], s83 offen offset:3072 lds
    v_mfma_f32_16x16x32_bf16 v[68:71], v[212:215], a[168:171], v[68:71]
    v_add_u32 v2, s91, v2
    v_add_u32 v2, 128, v2
    v_mfma_f32_16x16x32_bf16 v[72:75], v[208:211], a[152:155], v[72:75]
    v_mfma_f32_16x16x32_bf16 v[72:75], v[212:215], a[172:175], v[72:75]
    s_waitcnt vmcnt(9) lgkmcnt(0)
    s_barrier
    v_mfma_f32_16x16x32_bf16 v[36:39], v[216:219], a[136:139], v[36:39]
    s_add_u32 m0, s77, 49152
    ds_read_b64_tr_b16 v[200:201], v5 offset:16384
    ds_read_b64_tr_b16 v[202:203], v5 offset:16896
    v_mfma_f32_16x16x32_bf16 v[36:39], v[220:223], a[156:159], v[36:39]
    buffer_load_dwordx4 v2, s[8:11], 0 offen offset:0 lds
    ds_read_b64_tr_b16 v[204:205], v5 offset:17408
    v_mfma_f32_16x16x32_bf16 v[40:43], v[216:219], a[140:143], v[40:43]
    ds_read_b64_tr_b16 v[206:207], v5 offset:17920
    v_mfma_f32_16x16x32_bf16 v[40:43], v[220:223], a[160:163], v[40:43]
    ds_read_b128 a[176:179], v3 offset:20480
    v_mfma_f32_16x16x32_bf16 v[44:47], v[216:219], a[144:147], v[44:47]
    ds_read_b128 a[180:183], v3 offset:22528
    buffer_load_dwordx4 v2, s[12:15], 0 offen offset:2048 lds
    v_mfma_f32_16x16x32_bf16 v[44:47], v[220:223], a[164:167], v[44:47]
    ds_read_b128 a[184:187], v3 offset:24576
    v_mfma_f32_16x16x32_bf16 v[48:51], v[216:219], a[148:151], v[48:51]
    ds_read_b128 a[188:191], v3 offset:26624
    v_mfma_f32_16x16x32_bf16 v[48:51], v[220:223], a[168:171], v[48:51]
    ds_read_b128 a[192:195], v3 offset:28672
    v_mfma_f32_16x16x32_bf16 v[52:55], v[216:219], a[152:155], v[52:55]
    ds_read_b128 a[196:199], v4 offset:20480
    buffer_load_dwordx4 v2, s[8:11], s83 offen offset:1024 lds
    v_mfma_f32_16x16x32_bf16 v[52:55], v[220:223], a[172:175], v[52:55]
    ds_read_b128 a[200:203], v4 offset:22528
    v_mfma_f32_16x16x32_bf16 v[76:79], v[224:227], a[136:139], v[76:79]
    ds_read_b128 a[204:207], v4 offset:24576
    v_mfma_f32_16x16x32_bf16 v[76:79], v[228:231], a[156:159], v[76:79]
    s_cmp_eq_u32 s90, 0
    s_cselect_b32 s91, s99, 229376
    ds_read_b128 a[208:211], v4 offset:26624
    v_mfma_f32_16x16x32_bf16 v[80:83], v[224:227], a[140:143], v[80:83]
    ds_read_b128 a[212:215], v4 offset:28672
    buffer_load_dwordx4 v2, s[12:15], s83 offen offset:3072 lds
    v_mfma_f32_16x16x32_bf16 v[80:83], v[228:231], a[160:163], v[80:83]
    ds_read_b64_tr_b16 v[208:209], v5 offset:18432
    v_add_u32 v2, s91, v2
    v_mfma_f32_16x16x32_bf16 v[84:87], v[224:227], a[144:147], v[84:87]
    ds_read_b64_tr_b16 v[210:211], v5 offset:18944
    v_mfma_f32_16x16x32_bf16 v[84:87], v[228:231], a[164:167], v[84:87]
    s_add_u32 m0, s77, 0
    ds_read_b64_tr_b16 v[212:213], v5 offset:19456
    v_mfma_f32_16x16x32_bf16 v[88:91], v[224:227], a[148:151], v[88:91]
    ds_read_b64_tr_b16 v[214:215], v5 offset:19968
    buffer_load_dwordx4 v2, s[8:11], 0 offen offset:0 lds
    v_mfma_f32_16x16x32_bf16 v[88:91], v[228:231], a[168:171], v[88:91]
    v_mfma_f32_16x16x32_bf16 v[92:95], v[224:227], a[152:155], v[92:95]
    v_mfma_f32_16x16x32_bf16 v[92:95], v[228:231], a[172:175], v[92:95]
    s_waitcnt lgkmcnt(0)
    v_mfma_f32_16x16x32_bf16 v[16:19], v[200:203], a[176:179], v[16:19]
    ds_read_b64_tr_b16 v[216:217], v6 offset:16384
    v_mfma_f32_16x16x32_bf16 v[16:19], v[204:207], a[196:199], v[16:19]
    ds_read_b64_tr_b16 v[218:219], v6 offset:16896
    buffer_load_dwordx4 v2, s[12:15], 0 offen offset:2048 lds
    v_mfma_f32_16x16x32_bf16 v[20:23], v[200:203], a[180:183], v[20:23]
    ds_read_b64_tr_b16 v[220:221], v6 offset:17408
    v_mfma_f32_16x16x32_bf16 v[20:23], v[204:207], a[200:203], v[20:23]
    ds_read_b64_tr_b16 v[222:223], v6 offset:17920
    v_mfma_f32_16x16x32_bf16 v[24:27], v[200:203], a[184:187], v[24:27]
    ds_read_b64_tr_b16 v[224:225], v6 offset:18432
    buffer_load_dwordx4 v2, s[8:11], s83 offen offset:1024 lds
    v_mfma_f32_16x16x32_bf16 v[24:27], v[204:207], a[204:207], v[24:27]
    ds_read_b64_tr_b16 v[226:227], v6 offset:18944
    v_mfma_f32_16x16x32_bf16 v[28:31], v[200:203], a[188:191], v[28:31]
    ds_read_b64_tr_b16 v[228:229], v6 offset:19456
    v_mfma_f32_16x16x32_bf16 v[28:31], v[204:207], a[208:211], v[28:31]
    s_cmp_eq_u32 s90, 1
    s_cselect_b32 s91, s99, 229376
    ds_read_b64_tr_b16 v[230:231], v6 offset:19968
    v_mfma_f32_16x16x32_bf16 v[32:35], v[200:203], a[192:195], v[32:35]
    buffer_load_dwordx4 v2, s[12:15], s83 offen offset:3072 lds
    v_mfma_f32_16x16x32_bf16 v[32:35], v[204:207], a[212:215], v[32:35]
    v_add_u32 v2, s91, v2
    v_mfma_f32_16x16x32_bf16 v[56:59], v[208:211], a[176:179], v[56:59]
    v_mfma_f32_16x16x32_bf16 v[56:59], v[212:215], a[196:199], v[56:59]
    v_mfma_f32_16x16x32_bf16 v[60:63], v[208:211], a[180:183], v[60:63]
    buffer_load_dword v14, v15, s[32:35], 0 offen sc1
    v_mfma_f32_16x16x32_bf16 v[60:63], v[212:215], a[200:203], v[60:63]
    v_mfma_f32_16x16x32_bf16 v[64:67], v[208:211], a[184:187], v[64:67]
    v_mfma_f32_16x16x32_bf16 v[64:67], v[212:215], a[204:207], v[64:67]
    v_mfma_f32_16x16x32_bf16 v[68:71], v[208:211], a[188:191], v[68:71]
    v_mfma_f32_16x16x32_bf16 v[68:71], v[212:215], a[208:211], v[68:71]
    v_mfma_f32_16x16x32_bf16 v[72:75], v[208:211], a[192:195], v[72:75]
    v_mfma_f32_16x16x32_bf16 v[72:75], v[212:215], a[212:215], v[72:75]
    s_waitcnt vmcnt(9) lgkmcnt(0)
    s_barrier
    v_mfma_f32_16x16x32_bf16 v[36:39], v[216:219], a[176:179], v[36:39]
    s_add_u32 m0, s77, 16384
    ds_read_b64_tr_b16 v[200:201], v5 offset:32768
    ds_read_b64_tr_b16 v[202:203], v5 offset:33280
    v_mfma_f32_16x16x32_bf16 v[36:39], v[220:223], a[196:199], v[36:39]
    buffer_load_dwordx4 v2, s[8:11], 0 offen offset:0 lds
    ds_read_b64_tr_b16 v[204:205], v5 offset:33792
    v_mfma_f32_16x16x32_bf16 v[40:43], v[216:219], a[180:183], v[40:43]
    ds_read_b64_tr_b16 v[206:207], v5 offset:34304
    v_mfma_f32_16x16x32_bf16 v[40:43], v[220:223], a[200:203], v[40:43]
    ds_read_b128 a[216:219], v3 offset:40960
    v_mfma_f32_16x16x32_bf16 v[44:47], v[216:219], a[184:187], v[44:47]
    ds_read_b128 a[220:223], v3 offset:43008
    buffer_load_dwordx4 v2, s[12:15], 0 offen offset:2048 lds
    v_mfma_f32_16x16x32_bf16 v[44:47], v[220:223], a[204:207], v[44:47]
    ds_read_b128 a[224:227], v3 offset:45056
    v_mfma_f32_16x16x32_bf16 v[48:51], v[216:219], a[188:191], v[48:51]
    ds_read_b128 a[228:231], v3 offset:47104
    v_mfma_f32_16x16x32_bf16 v[48:51], v[220:223], a[208:211], v[48:51]
    ds_read_b128 a[232:235], v3 offset:49152
    v_mfma_f32_16x16x32_bf16 v[52:55], v[216:219], a[192:195], v[52:55]
    ds_read_b128 a[236:239], v4 offset:40960
    buffer_load_dwordx4 v2, s[8:11], s83 offen offset:1024 lds
    v_mfma_f32_16x16x32_bf16 v[52:55], v[220:223], a[212:215], v[52:55]
    ds_read_b128 a[240:243], v4 offset:43008
    v_mfma_f32_16x16x32_bf16 v[76:79], v[224:227], a[176:179], v[76:79]
    ds_read_b128 a[244:247], v4 offset:45056
    v_mfma_f32_16x16x32_bf16 v[76:79], v[228:231], a[196:199], v[76:79]
    s_cmp_eq_u32 s90, 2
    s_cselect_b32 s91, s99, 229376
    ds_read_b128 a[248:251], v4 offset:47104
    v_mfma_f32_16x16x32_bf16 v[80:83], v[224:227], a[180:183], v[80:83]
    ds_read_b128 a[252:255], v4 offset:49152
    buffer_load_dwordx4 v2, s[12:15], s83 offen offset:3072 lds
    v_mfma_f32_16x16x32_bf16 v[80:83], v[228:231], a[200:203], v[80:83]
    ds_read_b64_tr_b16 v[208:209], v5 offset:34816
    v_add_u32 v2, s91, v2
    v_mfma_f32_16x16x32_bf16 v[84:87], v[224:227], a[184:187], v[84:87]
    ds_read_b64_tr_b16 v[210:211], v5 offset:35328
    v_mfma_f32_16x16x32_bf16 v[84:87], v[228:231], a[204:207], v[84:87]
    ds_read_b64_tr_b16 v[212:213], v5 offset:35840
    v_mfma_f32_16x16x32_bf16 v[88:91], v[224:227], a[188:191], v[88:91]
    ds_read_b64_tr_b16 v[214:215], v5 offset:36352
    v_mfma_f32_16x16x32_bf16 v[88:91], v[228:231], a[208:211], v[88:91]
    v_mfma_f32_16x16x32_bf16 v[92:95], v[224:227], a[192:195], v[92:95]
    v_mfma_f32_16x16x32_bf16 v[92:95], v[228:231], a[212:215], v[92:95]
    s_waitcnt lgkmcnt(0)
    v_mfma_f32_16x16x32_bf16 v[16:19], v[200:203], a[216:219], v[16:19]
    ds_read_b64_tr_b16 v[216:217], v6 offset:32768
    v_mfma_f32_16x16x32_bf16 v[16:19], v[204:207], a[236:239], v[16:19]
    ds_read_b64_tr_b16 v[218:219], v6 offset:33280
    v_mfma_f32_16x16x32_bf16 v[20:23], v[200:203], a[220:223], v[20:23]
    ds_read_b64_tr_b16 v[220:221], v6 offset:33792
    v_mfma_f32_16x16x32_bf16 v[20:23], v[204:207], a[240:243], v[20:23]
    ds_read_b64_tr_b16 v[222:223], v6 offset:34304
    v_mfma_f32_16x16x32_bf16 v[24:27], v[200:203], a[224:227], v[24:27]
    ds_read_b64_tr_b16 v[224:225], v6 offset:34816
    v_mfma_f32_16x16x32_bf16 v[24:27], v[204:207], a[244:247], v[24:27]
    ds_read_b64_tr_b16 v[226:227], v6 offset:35328
    v_mfma_f32_16x16x32_bf16 v[28:31], v[200:203], a[228:231], v[28:31]
    ds_read_b64_tr_b16 v[228:229], v6 offset:35840
    v_mfma_f32_16x16x32_bf16 v[28:31], v[204:207], a[248:251], v[28:31]
    ds_read_b64_tr_b16 v[230:231], v6 offset:36352
    v_mfma_f32_16x16x32_bf16 v[32:35], v[200:203], a[232:235], v[32:35]
    v_mfma_f32_16x16x32_bf16 v[32:35], v[204:207], a[252:255], v[32:35]
    v_mfma_f32_16x16x32_bf16 v[56:59], v[208:211], a[216:219], v[56:59]
    v_mfma_f32_16x16x32_bf16 v[56:59], v[212:215], a[236:239], v[56:59]
    v_mfma_f32_16x16x32_bf16 v[60:63], v[208:211], a[220:223], v[60:63]
    v_mfma_f32_16x16x32_bf16 v[60:63], v[212:215], a[240:243], v[60:63]
    v_mfma_f32_16x16x32_bf16 v[64:67], v[208:211], a[224:227], v[64:67]
    v_mfma_f32_16x16x32_bf16 v[64:67], v[212:215], a[244:247], v[64:67]
    v_mfma_f32_16x16x32_bf16 v[68:71], v[208:211], a[228:231], v[68:71]
    v_mfma_f32_16x16x32_bf16 v[68:71], v[212:215], a[248:251], v[68:71]
    v_mfma_f32_16x16x32_bf16 v[72:75], v[208:211], a[232:235], v[72:75]
    v_mfma_f32_16x16x32_bf16 v[72:75], v[212:215], a[252:255], v[72:75]
    s_waitcnt vmcnt(9) lgkmcnt(0)
    s_barrier
    v_mfma_f32_16x16x32_bf16 v[36:39], v[216:219], a[216:219], v[36:39]
    s_add_u32 m0, s77, 32768
    ds_read_b64_tr_b16 v[200:201], v5 offset:49152
    v_mfma_f32_16x16x32_bf16 v[36:39], v[220:223], a[236:239], v[36:39]
    ds_read_b64_tr_b16 v[202:203], v5 offset:49664
    buffer_load_dwordx4 v2, s[8:11], 0 offen offset:0 lds
    v_mfma_f32_16x16x32_bf16 v[40:43], v[216:219], a[220:223], v[40:43]
    ds_read_b64_tr_b16 v[204:205], v5 offset:50176
    v_mfma_f32_16x16x32_bf16 v[40:43], v[220:223], a[240:243], v[40:43]
    ds_read_b64_tr_b16 v[206:207], v5 offset:50688
    v_mfma_f32_16x16x32_bf16 v[44:47], v[216:219], a[224:227], v[44:47]
    ds_read_b64_tr_b16 v[208:209], v5 offset:51200
    buffer_load_dwordx4 v2, s[12:15], 0 offen offset:2048 lds
    v_mfma_f32_16x16x32_bf16 v[44:47], v[220:223], a[244:247], v[44:47]
    ds_read_b64_tr_b16 v[210:211], v5 offset:51712
    v_mfma_f32_16x16x32_bf16 v[48:51], v[216:219], a[228:231], v[48:51]
    ds_read_b64_tr_b16 v[212:213], v5 offset:52224
    v_mfma_f32_16x16x32_bf16 v[48:51], v[220:223], a[248:251], v[48:51]
    ds_read_b64_tr_b16 v[214:215], v5 offset:52736
    v_mfma_f32_16x16x32_bf16 v[52:55], v[216:219], a[232:235], v[52:55]
    buffer_load_dwordx4 v2, s[8:11], s83 offen offset:1024 lds
    v_mfma_f32_16x16x32_bf16 v[52:55], v[220:223], a[252:255], v[52:55]
    v_mfma_f32_16x16x32_bf16 v[76:79], v[224:227], a[216:219], v[76:79]
    v_mfma_f32_16x16x32_bf16 v[76:79], v[228:231], a[236:239], v[76:79]
    s_cmp_eq_u32 s90, 3
    s_cselect_b32 s91, s99, 229376
    v_mfma_f32_16x16x32_bf16 v[80:83], v[224:227], a[220:223], v[80:83]
    buffer_load_dwordx4 v2, s[12:15], s83 offen offset:3072 lds
    v_mfma_f32_16x16x32_bf16 v[80:83], v[228:231], a[240:243], v[80:83]
    v_add_u32 v2, s91, v2
    v_mfma_f32_16x16x32_bf16 v[84:87], v[224:227], a[224:227], v[84:87]
    v_mfma_f32_16x16x32_bf16 v[84:87], v[228:231], a[244:247], v[84:87]
    s_add_u32 m0, s76, 0
    v_mfma_f32_16x16x32_bf16 v[88:91], v[224:227], a[228:231], v[88:91]
    buffer_load_dwordx4 v7, s[16:19], 0 offen offset:0 lds
    v_mfma_f32_16x16x32_bf16 v[88:91], v[228:231], a[248:251], v[88:91]
    v_mfma_f32_16x16x32_bf16 v[92:95], v[224:227], a[232:235], v[92:95]
    v_mfma_f32_16x16x32_bf16 v[92:95], v[228:231], a[252:255], v[92:95]
    s_waitcnt lgkmcnt(0)
    v_mfma_f32_16x16x32_bf16 v[96:99], v[200:203], v[176:179], 0
    ds_read_b64_tr_b16 v[216:217], v6 offset:49152
    v_mfma_f32_16x16x32_bf16 v[96:99], v[204:207], v[196:199], v[96:99]
    ds_read_b64_tr_b16 v[218:219], v6 offset:49664
    buffer_load_dwordx4 v7, s[16:19], s84 offen offset:1024 lds
    v_mfma_f32_16x16x32_bf16 v[100:103], v[200:203], v[180:183], 0
    ds_read_b64_tr_b16 v[220:221], v6 offset:50176
    v_mul_f32 v232, s89, v16
    v_mul_f32 v233, s89, v17
    v_mfma_f32_16x16x32_bf16 v[100:103], v[204:207], a[0:3], v[100:103]
    ds_read_b64_tr_b16 v[222:223], v6 offset:50688
    v_mul_f32 v234, s89, v18
    v_mul_f32 v235, s89, v19
    v_mfma_f32_16x16x32_bf16 v[104:107], v[200:203], v[184:187], 0
    ds_read_b64_tr_b16 v[224:225], v6 offset:51200
    buffer_load_dwordx4 v7, s[16:19], s85 offen offset:2048 lds
    v_mul_f32 v236, s89, v36
    v_mfma_f32_16x16x32_bf16 v[104:107], v[204:207], a[4:7], v[104:107]
    ds_read_b64_tr_b16 v[226:227], v6 offset:51712
    v_mul_f32 v237, s89, v37
    v_mul_f32 v238, s89, v38
    v_mfma_f32_16x16x32_bf16 v[108:111], v[200:203], v[188:191], 0
    ds_read_b64_tr_b16 v[228:229], v6 offset:52224
    v_mul_f32 v239, s89, v39
    v_mul_f32 v56, v16, v56
    v_mfma_f32_16x16x32_bf16 v[108:111], v[204:207], a[8:11], v[108:111]
    s_cmp_eq_u32 s100, 0
    s_cselect_b32 s91, s101, 114688
    ds_read_b64_tr_b16 v[230:231], v6 offset:52736
    v_mul_f32 v57, v17, v57
    v_mfma_f32_16x16x32_bf16 v[112:115], v[200:203], v[192:195], 0
    buffer_load_dwordx4 v7, s[16:19], s86 offen offset:3072 lds
    v_exp_f32 v232, v232
    v_mfma_f32_16x16x32_bf16 v[112:115], v[204:207], a[12:15], v[112:115]
    v_add_u32 v7, s91, v7
    v_exp_f32 v233, v233
    v_mfma_f32_16x16x32_bf16 v[136:139], v[208:211], v[176:179], 0
    v_exp_f32 v234, v234
    v_mul_f32 v58, v18, v58
    v_mfma_f32_16x16x32_bf16 v[136:139], v[212:215], v[196:199], v[136:139]
    s_add_u32 m0, s76, 4096
    v_exp_f32 v235, v235
    v_mul_f32 v59, v19, v59
    v_mfma_f32_16x16x32_bf16 v[140:143], v[208:211], v[180:183], 0
    buffer_load_dwordx4 v7, s[16:19], 0 offen offset:0 lds
    v_exp_f32 v236, v236
    v_mfma_f32_16x16x32_bf16 v[140:143], v[212:215], a[0:3], v[140:143]
    v_mul_f32 v76, v36, v76
    v_exp_f32 v237, v237
    v_mfma_f32_16x16x32_bf16 v[144:147], v[208:211], v[184:187], 0
    v_mul_f32 v77, v37, v77
    v_exp_f32 v238, v238
    v_mfma_f32_16x16x32_bf16 v[144:147], v[212:215], a[4:7], v[144:147]
    v_mul_f32 v78, v38, v78
    v_exp_f32 v239, v239
    v_mfma_f32_16x16x32_bf16 v[148:151], v[208:211], v[188:191], 0
    buffer_load_dwordx4 v7, s[16:19], s84 offen offset:1024 lds
    v_mul_f32 v79, v39, v79
    v_add_f32 v232, 1.0, v232
    v_mfma_f32_16x16x32_bf16 v[148:151], v[212:215], a[8:11], v[148:151]
    v_add_f32 v233, 1.0, v233
    v_add_f32 v234, 1.0, v234
    v_add_f32 v235, 1.0, v235
    v_mfma_f32_16x16x32_bf16 v[152:155], v[208:211], v[192:195], 0
    v_add_f32 v236, 1.0, v236
    v_add_f32 v237, 1.0, v237
    v_add_f32 v238, 1.0, v238
    v_mfma_f32_16x16x32_bf16 v[152:155], v[212:215], a[12:15], v[152:155]
    s_waitcnt vmcnt(15) lgkmcnt(0)
    s_barrier
    v_add_f32 v239, 1.0, v239
    v_mfma_f32_16x16x32_bf16 v[116:119], v[216:219], v[176:179], 0
    ds_read_b64_tr_b16 v[200:201], v5 offset:0
    v_rcp_f32 v16, v232
    v_mfma_f32_16x16x32_bf16 v[116:119], v[220:223], v[196:199], v[116:119]
    ds_read_b64_tr_b16 v[202:203], v5 offset:512
    buffer_load_dwordx4 v7, s[16:19], s85 offen offset:2048 lds
    v_mul_f32 v56, v16, v56
    v_mfma_f32_16x16x32_bf16 v[120:123], v[216:219], v[180:183], 0
    ds_read_b64_tr_b16 v[204:205], v5 offset:1024
    v_rcp_f32 v17, v233
    v_mfma_f32_16x16x32_bf16 v[120:123], v[220:223], a[0:3], v[120:123]
    s_cmp_eq_u32 s100, 1
    s_cselect_b32 s91, s101, 114688
    ds_read_b64_tr_b16 v[206:207], v5 offset:1536
    v_mul_f32 v57, v17, v57
    v_mfma_f32_16x16x32_bf16 v[124:127], v[216:219], v[184:187], 0
    ds_read_b64_tr_b16 v[208:209], v5 offset:2048
    buffer_load_dwordx4 v7, s[16:19], s86 offen offset:3072 lds
    v_cvt_pk_bf16_f32 v240, v56, v57
    v_mfma_f32_16x16x32_bf16 v[124:127], v[220:223], a[4:7], v[124:127]
    ds_read_b64_tr_b16 v[210:211], v5 offset:2560
    v_add_u32 v7, s91, v7
    v_mul_f32 v232, s89, v20
    v_mfma_f32_16x16x32_bf16 v[128:131], v[216:219], v[188:191], 0
    ds_read_b64_tr_b16 v[212:213], v5 offset:3072
    v_rcp_f32 v18, v234
    v_mfma_f32_16x16x32_bf16 v[128:131], v[220:223], a[8:11], v[128:131]
    s_add_u32 m0, s77, 49152
    ds_read_b64_tr_b16 v[214:215], v5 offset:3584
    v_rcp_f32 v19, v235
    v_mfma_f32_16x16x32_bf16 v[132:135], v[216:219], v[192:195], 0
    buffer_load_dwordx4 v2, s[8:11], 0 offen offset:0 lds
    v_mul_f32 v58, v18, v58
    v_mul_f32 v59, v19, v59
    v_mfma_f32_16x16x32_bf16 v[132:135], v[220:223], a[12:15], v[132:135]
    v_rcp_f32 v36, v236
    v_cvt_pk_bf16_f32 v241, v58, v59
    v_mfma_f32_16x16x32_bf16 v[156:159], v[224:227], v[176:179], 0
    v_rcp_f32 v37, v237
    v_mul_f32 v76, v36, v76
    v_mfma_f32_16x16x32_bf16 v[156:159], v[228:231], v[196:199], v[156:159]
    v_rcp_f32 v38, v238
    v_mul_f32 v77, v37, v77
    v_mfma_f32_16x16x32_bf16 v[160:163], v[224:227], v[180:183], 0
    buffer_load_dwordx4 v2, s[12:15], 0 offen offset:2048 lds
    v_rcp_f32 v39, v239
    v_mfma_f32_16x16x32_bf16 v[160:163], v[228:231], a[0:3], v[160:163]
    v_mul_f32 v78, v38, v78
    v_cvt_pk_bf16_f32 v242, v76, v77
    v_mul_f32 v79, v39, v79
    v_mfma_f32_16x16x32_bf16 v[164:167], v[224:227], v[184:187], 0
    v_cvt_pk_bf16_f32 v243, v78, v79
    v_mul_f32 v233, s89, v21
    v_mul_f32 v234, s89, v22
    v_mfma_f32_16x16x32_bf16 v[164:167], v[228:231], a[4:7], v[164:167]
    buffer_store_dwordx4 v[240:243], v8, s[24:27], s87 offen offset:0 sc1
    v_mul_f32 v235, s89, v23
    v_mul_f32 v236, s89, v40
    v_mfma_f32_16x16x32_bf16 v[168:171], v[224:227], v[188:191], 0
    buffer_load_dwordx4 v2, s[8:11], s83 offen offset:1024 lds
    v_mul_f32 v237, s89, v41
    v_mul_f32 v238, s89, v42
    v_mfma_f32_16x16x32_bf16 v[168:171], v[228:231], a[8:11], v[168:171]
    v_mul_f32 v239, s89, v43
    v_exp_f32 v232, v232
    v_mfma_f32_16x16x32_bf16 v[172:175], v[224:227], v[192:195], 0
    v_mul_f32 v60, v20, v60
    v_exp_f32 v233, v233
    v_mfma_f32_16x16x32_bf16 v[172:175], v[228:231], a[12:15], v[172:175]
    s_waitcnt lgkmcnt(0)
    v_mul_f32 v61, v21, v61
    v_exp_f32 v234, v234
    v_mfma_f32_16x16x32_bf16 v[96:99], v[200:203], a[16:19], v[96:99]
    s_cmp_eq_u32 s90, 4
    s_cselect_b32 s91, s99, 229376
    ds_read_b64_tr_b16 v[216:217], v6 offset:0
    v_mfma_f32_16x16x32_bf16 v[96:99], v[204:207], a[36:39], v[96:99]
    ds_read_b64_tr_b16 v[218:219], v6 offset:512
    buffer_load_dwordx4 v2, s[12:15], s83 offen offset:3072 lds
    v_mfma_f32_16x16x32_bf16 v[100:103], v[200:203], a[20:23], v[100:103]
    ds_read_b64_tr_b16 v[220:221], v6 offset:1024
    v_add_u32 v2, s91, v2
    v_mfma_f32_16x16x32_bf16 v[100:103], v[204:207], a[40:43], v[100:103]
    ds_read_b64_tr_b16 v[222:223], v6 offset:1536
    v_mul_f32 v62, v22, v62
    v_mfma_f32_16x16x32_bf16 v[104:107], v[200:203], a[24:27], v[104:107]
    ds_read_b64_tr_b16 v[224:225], v6 offset:2048
    v_mul_f32 v63, v23, v63
    v_mfma_f32_16x16x32_bf16 v[104:107], v[204:207], a[44:47], v[104:107]
    ds_read_b64_tr_b16 v[226:227], v6 offset:2560
    v_mul_f32 v80, v40, v80
    v_mfma_f32_16x16x32_bf16 v[108:111], v[200:203], a[28:31], v[108:111]
    ds_read_b64_tr_b16 v[228:229], v6 offset:3072
    v_mul_f32 v81, v41, v81
    v_mfma_f32_16x16x32_bf16 v[108:111], v[204:207], a[48:51], v[108:111]
    ds_read_b64_tr_b16 v[230:231], v6 offset:3584
    v_mul_f32 v82, v42, v82
    v_mfma_f32_16x16x32_bf16 v[112:115], v[200:203], a[32:35], v[112:115]
    ds_read_b128 v[176:179], v249 offset:0
    v_mul_f32 v83, v43, v83
    v_mfma_f32_16x16x32_bf16 v[112:115], v[204:207], a[52:55], v[112:115]
    ds_read_b128 v[180:183], v249 offset:1024
    v_add_f32 v232, 1.0, v232
    v_mfma_f32_16x16x32_bf16 v[136:139], v[208:211], a[16:19], v[136:139]
    ds_read_b128 v[184:187], v249 offset:2048
    v_add_f32 v233, 1.0, v233
    v_mfma_f32_16x16x32_bf16 v[136:139], v[212:215], a[36:39], v[136:139]
    ds_read_b128 v[188:191], v249 offset:3072
    v_add_f32 v234, 1.0, v234
    v_mfma_f32_16x16x32_bf16 v[140:143], v[208:211], a[20:23], v[140:143]
    v_exp_f32 v235, v235
    v_mfma_f32_16x16x32_bf16 v[140:143], v[212:215], a[40:43], v[140:143]
    v_exp_f32 v236, v236
    v_mfma_f32_16x16x32_bf16 v[144:147], v[208:211], a[24:27], v[144:147]
    v_exp_f32 v237, v237
    v_mfma_f32_16x16x32_bf16 v[144:147], v[212:215], a[44:47], v[144:147]
    v_exp_f32 v238, v238
    v_mfma_f32_16x16x32_bf16 v[148:151], v[208:211], a[28:31], v[148:151]
    v_exp_f32 v239, v239
    v_mfma_f32_16x16x32_bf16 v[148:151], v[212:215], a[48:51], v[148:151]
    v_add_f32 v235, 1.0, v235
    v_add_f32 v236, 1.0, v236
    v_mfma_f32_16x16x32_bf16 v[152:155], v[208:211], a[32:35], v[152:155]
    v_add_f32 v237, 1.0, v237
    v_add_f32 v238, 1.0, v238
    v_mfma_f32_16x16x32_bf16 v[152:155], v[212:215], a[52:55], v[152:155]
    s_waitcnt vmcnt(17) lgkmcnt(0)
    s_barrier
    v_add_f32 v239, 1.0, v239
    v_mfma_f32_16x16x32_bf16 v[116:119], v[216:219], a[16:19], v[116:119]
    s_add_u32 m0, s77, 0
    ds_read_b64_tr_b16 v[200:201], v5 offset:16384
    v_mfma_f32_16x16x32_bf16 v[116:119], v[220:223], a[36:39], v[116:119]
    ds_read_b64_tr_b16 v[202:203], v5 offset:16896
    buffer_load_dwordx4 v2, s[8:11], 0 offen offset:0 lds
    v_mfma_f32_16x16x32_bf16 v[120:123], v[216:219], a[20:23], v[120:123]
    ds_read_b64_tr_b16 v[204:205], v5 offset:17408
    v_mfma_f32_16x16x32_bf16 v[120:123], v[220:223], a[40:43], v[120:123]
    ds_read_b64_tr_b16 v[206:207], v5 offset:17920
    v_mfma_f32_16x16x32_bf16 v[124:127], v[216:219], a[24:27], v[124:127]
    ds_read_b64_tr_b16 v[208:209], v5 offset:18432
    buffer_load_dwordx4 v2, s[12:15], 0 offen offset:2048 lds
    v_mfma_f32_16x16x32_bf16 v[124:127], v[220:223], a[44:47], v[124:127]
    ds_read_b64_tr_b16 v[210:211], v5 offset:18944
    v_mfma_f32_16x16x32_bf16 v[128:131], v[216:219], a[28:31], v[128:131]
    ds_read_b64_tr_b16 v[212:213], v5 offset:19456
    v_mfma_f32_16x16x32_bf16 v[128:131], v[220:223], a[48:51], v[128:131]
    ds_read_b64_tr_b16 v[214:215], v5 offset:19968
    v_mfma_f32_16x16x32_bf16 v[132:135], v[216:219], a[32:35], v[132:135]
    buffer_load_dwordx4 v2, s[8:11], s83 offen offset:1024 lds
    v_mfma_f32_16x16x32_bf16 v[132:135], v[220:223], a[52:55], v[132:135]
    v_rcp_f32 v20, v232
    v_mfma_f32_16x16x32_bf16 v[156:159], v[224:227], a[16:19], v[156:159]
    v_rcp_f32 v21, v233
    v_mfma_f32_16x16x32_bf16 v[156:159], v[228:231], a[36:39], v[156:159]
    s_cmp_eq_u32 s90, 5
    s_cselect_b32 s91, s99, 229376
    v_mul_f32 v60, v20, v60
    v_mfma_f32_16x16x32_bf16 v[160:163], v[224:227], a[20:23], v[160:163]
    buffer_load_dwordx4 v2, s[12:15], s83 offen offset:3072 lds
    v_mul_f32 v61, v21, v61
    v_mfma_f32_16x16x32_bf16 v[160:163], v[228:231], a[40:43], v[160:163]
    v_add_u32 v2, s91, v2
    v_cvt_pk_bf16_f32 v244, v60, v61
    v_mfma_f32_16x16x32_bf16 v[164:167], v[224:227], a[24:27], v[164:167]
    v_rcp_f32 v22, v234
    v_mfma_f32_16x16x32_bf16 v[164:167], v[228:231], a[44:47], v[164:167]
    s_add_u32 m0, s76, 8192
    v_rcp_f32 v23, v235
    v_mfma_f32_16x16x32_bf16 v[168:171], v[224:227], a[28:31], v[168:171]
    buffer_load_dwordx4 v7, s[16:19], 0 offen offset:0 lds
    v_mul_f32 v62, v22, v62
    v_mfma_f32_16x16x32_bf16 v[168:171], v[228:231], a[48:51], v[168:171]
    v_rcp_f32 v40, v236
    v_mfma_f32_16x16x32_bf16 v[172:175], v[224:227], a[32:35], v[172:175]
    v_mul_f32 v63, v23, v63
    v_mul_f32 v80, v40, v80
    v_mfma_f32_16x16x32_bf16 v[172:175], v[228:231], a[52:55], v[172:175]
    s_waitcnt lgkmcnt(0)
    v_rcp_f32 v41, v237
    v_mfma_f32_16x16x32_bf16 v[96:99], v[200:203], a[56:59], v[96:99]
    ds_read_b64_tr_b16 v[216:217], v6 offset:16384
    v_cvt_pk_bf16_f32 v245, v62, v63
    v_mfma_f32_16x16x32_bf16 v[96:99], v[204:207], a[76:79], v[96:99]
    ds_read_b64_tr_b16 v[218:219], v6 offset:16896
    buffer_load_dwordx4 v7, s[16:19], s84 offen offset:1024 lds
    v_mfma_f32_16x16x32_bf16 v[100:103], v[200:203], a[60:63], v[100:103]
    ds_read_b64_tr_b16 v[220:221], v6 offset:17408
    v_mul_f32 v81, v41, v81
    v_mfma_f32_16x16x32_bf16 v[100:103], v[204:207], a[80:83], v[100:103]
    ds_read_b64_tr_b16 v[222:223], v6 offset:17920
    v_cvt_pk_bf16_f32 v246, v80, v81
    v_mfma_f32_16x16x32_bf16 v[104:107], v[200:203], a[64:67], v[104:107]
    ds_read_b64_tr_b16 v[224:225], v6 offset:18432
    buffer_load_dwordx4 v7, s[16:19], s85 offen offset:2048 lds
    v_mfma_f32_16x16x32_bf16 v[104:107], v[204:207], a[84:87], v[104:107]
    ds_read_b64_tr_b16 v[226:227], v6 offset:18944
    v_mul_f32 v232, s89, v24
    v_mfma_f32_16x16x32_bf16 v[108:111], v[200:203], a[68:71], v[108:111]
    ds_read_b64_tr_b16 v[228:229], v6 offset:19456
    v_mul_f32 v233, s89, v25
    v_mfma_f32_16x16x32_bf16 v[108:111], v[204:207], a[88:91], v[108:111]
    s_cmp_eq_u32 s100, 2
    s_cselect_b32 s91, s101, 114688
    ds_read_b64_tr_b16 v[230:231], v6 offset:19968
    v_mfma_f32_16x16x32_bf16 v[112:115], v[200:203], a[72:75], v[112:115]
    buffer_load_dwordx4 v7, s[16:19], s86 offen offset:3072 lds
    v_mul_f32 v234, s89, v26
    v_mfma_f32_16x16x32_bf16 v[112:115], v[204:207], a[92:95], v[112:115]
    v_add_u32 v7, s91, v7
    v_mul_f32 v235, s89, v27
    v_mfma_f32_16x16x32_bf16 v[136:139], v[208:211], a[56:59], v[136:139]
    v_rcp_f32 v42, v238
    v_mfma_f32_16x16x32_bf16 v[136:139], v[212:215], a[76:79], v[136:139]
    s_add_u32 m0, s76, 12288
    v_rcp_f32 v43, v239
    v_mfma_f32_16x16x32_bf16 v[140:143], v[208:211], a[60:63], v[140:143]
    buffer_load_dwordx4 v7, s[16:19], 0 offen offset:0 lds
    v_mul_f32 v82, v42, v82
    v_mfma_f32_16x16x32_bf16 v[140:143], v[212:215], a[80:83], v[140:143]
    v_mul_f32 v83, v43, v83
    v_mul_f32 v236, s89, v44
    v_mfma_f32_16x16x32_bf16 v[144:147], v[208:211], a[64:67], v[144:147]
    v_cvt_pk_bf16_f32 v247, v82, v83
    v_mul_f32 v237, s89, v45
    v_mfma_f32_16x16x32_bf16 v[144:147], v[212:215], a[84:87], v[144:147]
    buffer_store_dwordx4 v[244:247], v8, s[24:27], s87 offen offset:1024 sc1
    v_mul_f32 v238, s89, v46
    v_mfma_f32_16x16x32_bf16 v[148:151], v[208:211], a[68:71], v[148:151]
    buffer_load_dwordx4 v7, s[16:19], s84 offen offset:1024 lds
    v_mul_f32 v239, s89, v47
    v_mfma_f32_16x16x32_bf16 v[148:151], v[212:215], a[88:91], v[148:151]
    v_exp_f32 v232, v232
    v_mfma_f32_16x16x32_bf16 v[152:155], v[208:211], a[72:75], v[152:155]
    v_mul_f32 v64, v24, v64
    v_mul_f32 v65, v25, v65
    v_mfma_f32_16x16x32_bf16 v[152:155], v[212:215], a[92:95], v[152:155]
    s_waitcnt vmcnt(24) lgkmcnt(0)
    s_barrier
    v_mul_f32 v66, v26, v66
    v_mfma_f32_16x16x32_bf16 v[116:119], v[216:219], a[56:59], v[116:119]
    ds_read_b64_tr_b16 v[200:201], v5 offset:32768
    v_mul_f32 v67, v27, v67
    v_mfma_f32_16x16x32_bf16 v[116:119], v[220:223], a[76:79], v[116:119]
    ds_read_b64_tr_b16 v[202:203], v5 offset:33280
    buffer_load_dwordx4 v7, s[16:19], s85 offen offset:2048 lds
    v_mfma_f32_16x16x32_bf16 v[120:123], v[216:219], a[60:63], v[120:123]
    ds_read_b64_tr_b16 v[204:205], v5 offset:33792
    v_mul_f32 v84, v44, v84
    v_mfma_f32_16x16x32_bf16 v[120:123], v[220:223], a[80:83], v[120:123]
    s_cmp_eq_u32 s100, 3
    s_cselect_b32 s91, s101, 114688
    ds_read_b64_tr_b16 v[206:207], v5 offset:34304
    v_mfma_f32_16x16x32_bf16 v[124:127], v[216:219], a[64:67], v[124:127]
    ds_read_b64_tr_b16 v[208:209], v5 offset:34816
    buffer_load_dwordx4 v7, s[16:19], s86 offen offset:3072 lds
    v_mfma_f32_16x16x32_bf16 v[124:127], v[220:223], a[84:87], v[124:127]
    ds_read_b64_tr_b16 v[210:211], v5 offset:35328
    v_add_u32 v7, s91, v7
    v_mfma_f32_16x16x32_bf16 v[128:131], v[216:219], a[68:71], v[128:131]
    ds_read_b64_tr_b16 v[212:213], v5 offset:35840
    v_mul_f32 v85, v45, v85
    v_mfma_f32_16x16x32_bf16 v[128:131], v[220:223], a[88:91], v[128:131]
    s_add_u32 m0, s77, 16384
    ds_read_b64_tr_b16 v[214:215], v5 offset:36352
    v_mul_f32 v86, v46, v86
    v_mfma_f32_16x16x32_bf16 v[132:135], v[216:219], a[72:75], v[132:135]
    buffer_load_dwordx4 v2, s[8:11], 0 offen offset:0 lds
    v_mul_f32 v87, v47, v87
    v_mfma_f32_16x16x32_bf16 v[132:135], v[220:223], a[92:95], v[132:135]
    v_exp_f32 v233, v233
    v_mfma_f32_16x16x32_bf16 v[156:159], v[224:227], a[56:59], v[156:159]
    v_exp_f32 v234, v234
    v_mfma_f32_16x16x32_bf16 v[156:159], v[228:231], a[76:79], v[156:159]
    v_exp_f32 v235, v235
    v_mfma_f32_16x16x32_bf16 v[160:163], v[224:227], a[60:63], v[160:163]
    buffer_load_dwordx4 v2, s[12:15], 0 offen offset:2048 lds
    v_add_f32 v232, 1.0, v232
    v_mfma_f32_16x16x32_bf16 v[160:163], v[228:231], a[80:83], v[160:163]
    v_exp_f32 v236, v236
    v_mfma_f32_16x16x32_bf16 v[164:167], v[224:227], a[64:67], v[164:167]
    v_exp_f32 v237, v237
    v_mfma_f32_16x16x32_bf16 v[164:167], v[228:231], a[84:87], v[164:167]
    v_exp_f32 v238, v238
    v_mfma_f32_16x16x32_bf16 v[168:171], v[224:227], a[68:71], v[168:171]
    buffer_load_dwordx4 v2, s[8:11], s83 offen offset:1024 lds
    v_add_f32 v233, 1.0, v233
    v_mfma_f32_16x16x32_bf16 v[168:171], v[228:231], a[88:91], v[168:171]
    v_exp_f32 v239, v239
    v_mfma_f32_16x16x32_bf16 v[172:175], v[224:227], a[72:75], v[172:175]
    v_add_f32 v234, 1.0, v234
    v_add_f32 v235, 1.0, v235
    v_mfma_f32_16x16x32_bf16 v[172:175], v[228:231], a[92:95], v[172:175]
    s_waitcnt lgkmcnt(0)
    v_add_f32 v236, 1.0, v236
    v_add_f32 v237, 1.0, v237
    v_mfma_f32_16x16x32_bf16 v[96:99], v[200:203], a[96:99], v[96:99]
    s_cmp_eq_u32 s90, 6
    s_cselect_b32 s91, s99, 229376
    ds_read_b64_tr_b16 v[216:217], v6 offset:32768
    v_mfma_f32_16x16x32_bf16 v[96:99], v[204:207], a[116:119], v[96:99]
    ds_read_b64_tr_b16 v[218:219], v6 offset:33280
    buffer_load_dwordx4 v2, s[12:15], s83 offen offset:3072 lds
    v_mfma_f32_16x16x32_bf16 v[100:103], v[200:203], a[100:103], v[100:103]
    ds_read_b64_tr_b16 v[220:221], v6 offset:33792
    v_add_u32 v2, s91, v2
    v_mfma_f32_16x16x32_bf16 v[100:103], v[204:207], a[120:123], v[100:103]
    s_add_u32 m0, s76, 16384
    ds_read_b64_tr_b16 v[222:223], v6 offset:34304
    v_add_f32 v238, 1.0, v238
    v_mfma_f32_16x16x32_bf16 v[104:107], v[200:203], a[104:107], v[104:107]
    ds_read_b64_tr_b16 v[224:225], v6 offset:34816
    buffer_load_dwordx4 v7, s[16:19], 0 offen offset:0 lds
    v_mfma_f32_16x16x32_bf16 v[104:107], v[204:207], a[124:127], v[104:107]
    ds_read_b64_tr_b16 v[226:227], v6 offset:35328
    v_add_f32 v239, 1.0, v239
    v_mfma_f32_16x16x32_bf16 v[108:111], v[200:203], a[108:111], v[108:111]
    ds_read_b64_tr_b16 v[228:229], v6 offset:35840
    v_mfma_f32_16x16x32_bf16 v[108:111], v[204:207], a[128:131], v[108:111]
    ds_read_b64_tr_b16 v[230:231], v6 offset:36352
    v_mfma_f32_16x16x32_bf16 v[112:115], v[200:203], a[112:115], v[112:115]
    buffer_load_dwordx4 v7, s[16:19], s84 offen offset:1024 lds
    v_mfma_f32_16x16x32_bf16 v[112:115], v[204:207], a[132:135], v[112:115]
    v_rcp_f32 v24, v232
    v_mfma_f32_16x16x32_bf16 v[136:139], v[208:211], a[96:99], v[136:139]
    v_rcp_f32 v25, v233
    v_mfma_f32_16x16x32_bf16 v[136:139], v[212:215], a[116:119], v[136:139]
    v_mul_f32 v64, v24, v64
    v_mul_f32 v65, v25, v65
    v_mfma_f32_16x16x32_bf16 v[140:143], v[208:211], a[100:103], v[140:143]
    buffer_load_dwordx4 v7, s[16:19], s85 offen offset:2048 lds
    v_cvt_pk_bf16_f32 v240, v64, v65
    v_mfma_f32_16x16x32_bf16 v[140:143], v[212:215], a[120:123], v[140:143]
    v_rcp_f32 v26, v234
    v_mfma_f32_16x16x32_bf16 v[144:147], v[208:211], a[104:107], v[144:147]
    v_rcp_f32 v27, v235
    v_mfma_f32_16x16x32_bf16 v[144:147], v[212:215], a[124:127], v[144:147]
    s_cmp_eq_u32 s100, 4
    s_cselect_b32 s91, s101, 114688
    v_mul_f32 v66, v26, v66
    v_mfma_f32_16x16x32_bf16 v[148:151], v[208:211], a[108:111], v[148:151]
    buffer_load_dwordx4 v7, s[16:19], s86 offen offset:3072 lds
    v_mul_f32 v67, v27, v67
    v_mfma_f32_16x16x32_bf16 v[148:151], v[212:215], a[128:131], v[148:151]
    v_add_u32 v7, s91, v7
    v_cvt_pk_bf16_f32 v241, v66, v67
    v_mfma_f32_16x16x32_bf16 v[152:155], v[208:211], a[112:115], v[152:155]
    v_rcp_f32 v44, v236
    v_mfma_f32_16x16x32_bf16 v[152:155], v[212:215], a[132:135], v[152:155]
    s_waitcnt vmcnt(21) lgkmcnt(0)
    s_barrier
    v_mul_f32 v84, v44, v84
    v_mfma_f32_16x16x32_bf16 v[116:119], v[216:219], a[96:99], v[116:119]
    s_add_u32 m0, s76, 20480
    ds_read_b64_tr_b16 v[200:201], v5 offset:49152
    v_mul_f32 v232, s89, v28
    v_mfma_f32_16x16x32_bf16 v[116:119], v[220:223], a[116:119], v[116:119]
    ds_read_b64_tr_b16 v[202:203], v5 offset:49664
    buffer_load_dwordx4 v7, s[16:19], 0 offen offset:0 lds
    v_mfma_f32_16x16x32_bf16 v[120:123], v[216:219], a[100:103], v[120:123]
    ds_read_b64_tr_b16 v[204:205], v5 offset:50176
    v_mul_f32 v233, s89, v29
    v_mfma_f32_16x16x32_bf16 v[120:123], v[220:223], a[120:123], v[120:123]
    ds_read_b64_tr_b16 v[206:207], v5 offset:50688
    v_mul_f32 v234, s89, v30
    v_mfma_f32_16x16x32_bf16 v[124:127], v[216:219], a[104:107], v[124:127]
    ds_read_b64_tr_b16 v[208:209], v5 offset:51200
    buffer_load_dwordx4 v7, s[16:19], s84 offen offset:1024 lds
    v_mfma_f32_16x16x32_bf16 v[124:127], v[220:223], a[124:127], v[124:127]
    ds_read_b64_tr_b16 v[210:211], v5 offset:51712
    v_mul_f32 v235, s89, v31
    v_mfma_f32_16x16x32_bf16 v[128:131], v[216:219], a[108:111], v[128:131]
    ds_read_b64_tr_b16 v[212:213], v5 offset:52224
    v_mul_f32 v236, s89, v48
    v_mfma_f32_16x16x32_bf16 v[128:131], v[220:223], a[128:131], v[128:131]
    ds_read_b64_tr_b16 v[214:215], v5 offset:52736
    v_mul_f32 v68, v28, v68
    v_mfma_f32_16x16x32_bf16 v[132:135], v[216:219], a[112:115], v[132:135]
    buffer_load_dwordx4 v7, s[16:19], s85 offen offset:2048 lds
    v_mul_f32 v69, v29, v69
    v_mfma_f32_16x16x32_bf16 v[132:135], v[220:223], a[132:135], v[132:135]
    v_rcp_f32 v45, v237
    v_mfma_f32_16x16x32_bf16 v[156:159], v[224:227], a[96:99], v[156:159]
    v_rcp_f32 v46, v238
    v_mfma_f32_16x16x32_bf16 v[156:159], v[228:231], a[116:119], v[156:159]
    s_cmp_eq_u32 s100, 5
    s_cselect_b32 s91, s101, 114688
    v_mul_f32 v85, v45, v85
    v_mfma_f32_16x16x32_bf16 v[160:163], v[224:227], a[100:103], v[160:163]
    buffer_load_dwordx4 v7, s[16:19], s86 offen offset:3072 lds
    v_mul_f32 v86, v46, v86
    v_mfma_f32_16x16x32_bf16 v[160:163], v[228:231], a[120:123], v[160:163]
    v_add_u32 v7, s91, v7
    v_cvt_pk_bf16_f32 v242, v84, v85
    v_mfma_f32_16x16x32_bf16 v[164:167], v[224:227], a[104:107], v[164:167]
    v_rcp_f32 v47, v239
    v_mfma_f32_16x16x32_bf16 v[164:167], v[228:231], a[124:127], v[164:167]
    s_add_u32 m0, s77, 32768
    v_mul_f32 v87, v47, v87
    v_mul_f32 v237, s89, v49
    v_mfma_f32_16x16x32_bf16 v[168:171], v[224:227], a[108:111], v[168:171]
    buffer_load_dwordx4 v7, s[16:19], 0 offen offset:0 lds
    v_cvt_pk_bf16_f32 v243, v86, v87
    v_mfma_f32_16x16x32_bf16 v[168:171], v[228:231], a[128:131], v[168:171]
    buffer_store_dwordx4 v[240:243], v8, s[24:27], s87 offen offset:2048 sc1
    v_mul_f32 v238, s89, v50
    v_mfma_f32_16x16x32_bf16 v[172:175], v[224:227], a[112:115], v[172:175]
    v_mul_f32 v239, s89, v51
    v_mul_f32 v70, v30, v70
    v_mfma_f32_16x16x32_bf16 v[172:175], v[228:231], a[132:135], v[172:175]
    s_waitcnt lgkmcnt(0)
    v_exp_f32 v232, v232
    v_mfma_f32_16x16x32_bf16 v[96:99], v[200:203], a[136:139], v[96:99]
    ds_read_b64_tr_b16 v[216:217], v6 offset:49152
    v_mul_f32 v71, v31, v71
    v_mfma_f32_16x16x32_bf16 v[96:99], v[204:207], a[156:159], v[96:99]
    ds_read_b64_tr_b16 v[218:219], v6 offset:49664
    buffer_load_dwordx4 v7, s[16:19], s84 offen offset:1024 lds
    v_mfma_f32_16x16x32_bf16 v[100:103], v[200:203], a[140:143], v[100:103]
    ds_read_b64_tr_b16 v[220:221], v6 offset:50176
    v_mul_f32 v88, v48, v88
    v_mfma_f32_16x16x32_bf16 v[100:103], v[204:207], a[160:163], v[100:103]
    ds_read_b64_tr_b16 v[222:223], v6 offset:50688
    v_mul_f32 v89, v49, v89
    v_mfma_f32_16x16x32_bf16 v[104:107], v[200:203], a[144:147], v[104:107]
    ds_read_b64_tr_b16 v[224:225], v6 offset:51200
    buffer_load_dwordx4 v7, s[16:19], s85 offen offset:2048 lds
    v_mfma_f32_16x16x32_bf16 v[104:107], v[204:207], a[164:167], v[104:107]
    ds_read_b64_tr_b16 v[226:227], v6 offset:51712
    v_mul_f32 v90, v50, v90
    v_mfma_f32_16x16x32_bf16 v[108:111], v[200:203], a[148:151], v[108:111]
    ds_read_b64_tr_b16 v[228:229], v6 offset:52224
    v_mul_f32 v91, v51, v91
    v_mfma_f32_16x16x32_bf16 v[108:111], v[204:207], a[168:171], v[108:111]
    s_cmp_eq_u32 s100, 6
    s_cselect_b32 s91, s101, 114688
    ds_read_b64_tr_b16 v[230:231], v6 offset:52736
    v_mfma_f32_16x16x32_bf16 v[112:115], v[200:203], a[152:155], v[112:115]
    buffer_load_dwordx4 v7, s[16:19], s86 offen offset:3072 lds
    v_add_f32 v232, 1.0, v232
    v_mfma_f32_16x16x32_bf16 v[112:115], v[204:207], a[172:175], v[112:115]
    v_add_u32 v7, s91, v7
    v_add_u32 v7, 57344, v7
    v_mfma_f32_16x16x32_bf16 v[136:139], v[208:211], a[136:139], v[136:139]
    v_exp_f32 v233, v233
    v_mfma_f32_16x16x32_bf16 v[136:139], v[212:215], a[156:159], v[136:139]
    v_exp_f32 v234, v234
    v_mfma_f32_16x16x32_bf16 v[140:143], v[208:211], a[140:143], v[140:143]
    v_exp_f32 v235, v235
    v_mfma_f32_16x16x32_bf16 v[140:143], v[212:215], a[160:163], v[140:143]
    v_exp_f32 v236, v236
    v_mfma_f32_16x16x32_bf16 v[144:147], v[208:211], a[144:147], v[144:147]
    v_exp_f32 v237, v237
    v_mfma_f32_16x16x32_bf16 v[144:147], v[212:215], a[164:167], v[144:147]
    v_exp_f32 v238, v238
    v_mfma_f32_16x16x32_bf16 v[148:151], v[208:211], a[148:151], v[148:151]
    v_exp_f32 v239, v239
    v_mfma_f32_16x16x32_bf16 v[148:151], v[212:215], a[168:171], v[148:151]
    v_add_f32 v233, 1.0, v233
    v_add_f32 v234, 1.0, v234
    v_mfma_f32_16x16x32_bf16 v[152:155], v[208:211], a[152:155], v[152:155]
    v_add_f32 v235, 1.0, v235
    v_add_f32 v236, 1.0, v236
    v_mfma_f32_16x16x32_bf16 v[152:155], v[212:215], a[172:175], v[152:155]
    s_waitcnt vmcnt(26) lgkmcnt(0)
    s_barrier
    v_add_f32 v237, 1.0, v237
    v_mfma_f32_16x16x32_bf16 v[116:119], v[216:219], a[136:139], v[116:119]
    s_add_u32 m0, s77, 49152
    ds_read_b64_tr_b16 v[200:201], v5 offset:0
    v_add_f32 v238, 1.0, v238
    v_mfma_f32_16x16x32_bf16 v[116:119], v[220:223], a[156:159], v[116:119]
    ds_read_b64_tr_b16 v[202:203], v5 offset:512
    buffer_load_dwordx4 v7, s[16:19], 0 offen offset:0 lds
    v_mfma_f32_16x16x32_bf16 v[120:123], v[216:219], a[140:143], v[120:123]
    ds_read_b64_tr_b16 v[204:205], v5 offset:1024
    v_add_f32 v239, 1.0, v239
    v_mfma_f32_16x16x32_bf16 v[120:123], v[220:223], a[160:163], v[120:123]
    ds_read_b64_tr_b16 v[206:207], v5 offset:1536
    v_mfma_f32_16x16x32_bf16 v[124:127], v[216:219], a[144:147], v[124:127]
    ds_read_b64_tr_b16 v[208:209], v5 offset:2048
    buffer_load_dwordx4 v7, s[16:19], s84 offen offset:1024 lds
    v_mfma_f32_16x16x32_bf16 v[124:127], v[220:223], a[164:167], v[124:127]
    ds_read_b64_tr_b16 v[210:211], v5 offset:2560
    v_mfma_f32_16x16x32_bf16 v[128:131], v[216:219], a[148:151], v[128:131]
    ds_read_b64_tr_b16 v[212:213], v5 offset:3072
    v_mfma_f32_16x16x32_bf16 v[128:131], v[220:223], a[168:171], v[128:131]
    ds_read_b64_tr_b16 v[214:215], v5 offset:3584
    v_mfma_f32_16x16x32_bf16 v[132:135], v[216:219], a[152:155], v[132:135]
    buffer_load_dwordx4 v7, s[16:19], s85 offen offset:2048 lds
    v_mfma_f32_16x16x32_bf16 v[132:135], v[220:223], a[172:175], v[132:135]
    v_rcp_f32 v28, v232
    v_mfma_f32_16x16x32_bf16 v[156:159], v[224:227], a[136:139], v[156:159]
    v_rcp_f32 v29, v233
    v_mfma_f32_16x16x32_bf16 v[156:159], v[228:231], a[156:159], v[156:159]
    s_cmp_eq_u32 s100, 0
    s_cselect_b32 s91, s101, 114688
    v_mul_f32 v68, v28, v68
    v_mfma_f32_16x16x32_bf16 v[160:163], v[224:227], a[140:143], v[160:163]
    buffer_load_dwordx4 v7, s[16:19], s86 offen offset:3072 lds
    v_mul_f32 v69, v29, v69
    v_mfma_f32_16x16x32_bf16 v[160:163], v[228:231], a[160:163], v[160:163]
    v_add_u32 v7, s91, v7
    v_cvt_pk_bf16_f32 v244, v68, v69
    v_mfma_f32_16x16x32_bf16 v[164:167], v[224:227], a[144:147], v[164:167]
    v_rcp_f32 v30, v234
    v_mfma_f32_16x16x32_bf16 v[164:167], v[228:231], a[164:167], v[164:167]
    v_rcp_f32 v31, v235
    v_mfma_f32_16x16x32_bf16 v[168:171], v[224:227], a[148:151], v[168:171]
    v_mul_f32 v70, v30, v70
    v_mul_f32 v71, v31, v71
    v_mfma_f32_16x16x32_bf16 v[168:171], v[228:231], a[168:171], v[168:171]
    v_rcp_f32 v48, v236
    v_mfma_f32_16x16x32_bf16 v[172:175], v[224:227], a[152:155], v[172:175]
    v_rcp_f32 v49, v237
    v_mfma_f32_16x16x32_bf16 v[172:175], v[228:231], a[172:175], v[172:175]
    s_waitcnt lgkmcnt(0)
    v_mul_f32 v88, v48, v88
    v_cvt_pk_bf16_f32 v245, v70, v71
    v_mfma_f32_16x16x32_bf16 v[96:99], v[200:203], a[176:179], v[96:99]
    ds_read_b64_tr_b16 v[216:217], v6 offset:0
    v_mul_f32 v89, v49, v89
    v_mfma_f32_16x16x32_bf16 v[96:99], v[204:207], a[196:199], v[96:99]
    ds_read_b64_tr_b16 v[218:219], v6 offset:512
    v_cvt_pk_bf16_f32 v246, v88, v89
    v_mfma_f32_16x16x32_bf16 v[100:103], v[200:203], a[180:183], v[100:103]
    ds_read_b64_tr_b16 v[220:221], v6 offset:1024
    v_mul_f32 v232, s89, v32
    v_mfma_f32_16x16x32_bf16 v[100:103], v[204:207], a[200:203], v[100:103]
    ds_read_b64_tr_b16 v[222:223], v6 offset:1536
    v_mul_f32 v233, s89, v33
    v_mfma_f32_16x16x32_bf16 v[104:107], v[200:203], a[184:187], v[104:107]
    ds_read_b64_tr_b16 v[224:225], v6 offset:2048
    v_mul_f32 v234, s89, v34
    v_mfma_f32_16x16x32_bf16 v[104:107], v[204:207], a[204:207], v[104:107]
    ds_read_b64_tr_b16 v[226:227], v6 offset:2560
    v_mul_f32 v235, s89, v35
    v_mfma_f32_16x16x32_bf16 v[108:111], v[200:203], a[188:191], v[108:111]
    ds_read_b64_tr_b16 v[228:229], v6 offset:3072
    v_mul_f32 v236, s89, v52
    v_mfma_f32_16x16x32_bf16 v[108:111], v[204:207], a[208:211], v[108:111]
    ds_read_b64_tr_b16 v[230:231], v6 offset:3584
    v_mul_f32 v237, s89, v53
    v_mfma_f32_16x16x32_bf16 v[112:115], v[200:203], a[192:195], v[112:115]
    v_rcp_f32 v50, v238
    v_mfma_f32_16x16x32_bf16 v[112:115], v[204:207], a[212:215], v[112:115]
    v_rcp_f32 v51, v239
    v_mfma_f32_16x16x32_bf16 v[136:139], v[208:211], a[176:179], v[136:139]
    v_mul_f32 v90, v50, v90
    v_mul_f32 v91, v51, v91
    v_mfma_f32_16x16x32_bf16 v[136:139], v[212:215], a[196:199], v[136:139]
    v_cvt_pk_bf16_f32 v247, v90, v91
    v_mul_f32 v238, s89, v54
    v_mfma_f32_16x16x32_bf16 v[140:143], v[208:211], a[180:183], v[140:143]
    buffer_store_dwordx4 v[244:247], v8, s[24:27], s87 offen offset:3072 sc1
    v_mul_f32 v239, s89, v55
    v_mfma_f32_16x16x32_bf16 v[140:143], v[212:215], a[200:203], v[140:143]
    v_exp_f32 v232, v232
    v_mfma_f32_16x16x32_bf16 v[144:147], v[208:211], a[184:187], v[144:147]
    v_mul_f32 v72, v32, v72
    v_mul_f32 v73, v33, v73
    v_mfma_f32_16x16x32_bf16 v[144:147], v[212:215], a[204:207], v[144:147]
    v_exp_f32 v233, v233
    v_mfma_f32_16x16x32_bf16 v[148:151], v[208:211], a[188:191], v[148:151]
    v_exp_f32 v234, v234
    v_mfma_f32_16x16x32_bf16 v[148:151], v[212:215], a[208:211], v[148:151]
    v_mul_f32 v74, v34, v74
    v_mul_f32 v75, v35, v75
    v_mfma_f32_16x16x32_bf16 v[152:155], v[208:211], a[192:195], v[152:155]
    v_exp_f32 v235, v235
    v_mfma_f32_16x16x32_bf16 v[152:155], v[212:215], a[212:215], v[152:155]
    s_waitcnt vmcnt(18) lgkmcnt(0)
    s_barrier
    v_mul_f32 v92, v52, v92
    v_mfma_f32_16x16x32_bf16 v[116:119], v[216:219], a[176:179], v[116:119]
    s_add_u32 m0, s77, 0
    ds_read_b64_tr_b16 v[200:201], v5 offset:16384
    v_mul_f32 v93, v53, v93
    v_mfma_f32_16x16x32_bf16 v[116:119], v[220:223], a[196:199], v[116:119]
    ds_read_b64_tr_b16 v[202:203], v5 offset:16896
    buffer_load_dwordx4 v7, s[16:19], 0 offen offset:0 lds
    v_mfma_f32_16x16x32_bf16 v[120:123], v[216:219], a[180:183], v[120:123]
    ds_read_b64_tr_b16 v[204:205], v5 offset:17408
    v_mul_f32 v94, v54, v94
    v_mfma_f32_16x16x32_bf16 v[120:123], v[220:223], a[200:203], v[120:123]
    ds_read_b64_tr_b16 v[206:207], v5 offset:17920
    v_mul_f32 v95, v55, v95
    v_mfma_f32_16x16x32_bf16 v[124:127], v[216:219], a[184:187], v[124:127]
    ds_read_b64_tr_b16 v[208:209], v5 offset:18432
    buffer_load_dwordx4 v7, s[16:19], s84 offen offset:1024 lds
    v_mfma_f32_16x16x32_bf16 v[124:127], v[220:223], a[204:207], v[124:127]
    ds_read_b64_tr_b16 v[210:211], v5 offset:18944
    v_add_f32 v232, 1.0, v232
    v_mfma_f32_16x16x32_bf16 v[128:131], v[216:219], a[188:191], v[128:131]
    ds_read_b64_tr_b16 v[212:213], v5 offset:19456
    v_add_f32 v233, 1.0, v233
    v_mfma_f32_16x16x32_bf16 v[128:131], v[220:223], a[208:211], v[128:131]
    ds_read_b64_tr_b16 v[214:215], v5 offset:19968
    v_add_f32 v234, 1.0, v234
    v_mfma_f32_16x16x32_bf16 v[132:135], v[216:219], a[192:195], v[132:135]
    buffer_load_dwordx4 v7, s[16:19], s85 offen offset:2048 lds
    v_add_f32 v235, 1.0, v235
    v_mfma_f32_16x16x32_bf16 v[132:135], v[220:223], a[212:215], v[132:135]
    v_exp_f32 v236, v236
    v_mfma_f32_16x16x32_bf16 v[156:159], v[224:227], a[176:179], v[156:159]
    v_exp_f32 v237, v237
    v_mfma_f32_16x16x32_bf16 v[156:159], v[228:231], a[196:199], v[156:159]
    s_cmp_eq_u32 s100, 1
    s_cselect_b32 s91, s101, 114688
    v_add_f32 v236, 1.0, v236
    v_mfma_f32_16x16x32_bf16 v[160:163], v[224:227], a[180:183], v[160:163]
    buffer_load_dwordx4 v7, s[16:19], s86 offen offset:3072 lds
    v_add_f32 v237, 1.0, v237
    v_mfma_f32_16x16x32_bf16 v[160:163], v[228:231], a[200:203], v[160:163]
    v_add_u32 v7, s91, v7
    v_mfma_f32_16x16x32_bf16 v[164:167], v[224:227], a[184:187], v[164:167]
    v_exp_f32 v238, v238
    v_mfma_f32_16x16x32_bf16 v[164:167], v[228:231], a[204:207], v[164:167]
    v_exp_f32 v239, v239
    v_mfma_f32_16x16x32_bf16 v[168:171], v[224:227], a[188:191], v[168:171]
    v_add_f32 v238, 1.0, v238
    v_add_f32 v239, 1.0, v239
    v_mfma_f32_16x16x32_bf16 v[168:171], v[228:231], a[208:211], v[168:171]
    v_rcp_f32 v32, v232
    v_mfma_f32_16x16x32_bf16 v[172:175], v[224:227], a[192:195], v[172:175]
    v_rcp_f32 v33, v233
    v_mfma_f32_16x16x32_bf16 v[172:175], v[228:231], a[212:215], v[172:175]
    s_waitcnt lgkmcnt(0)
    v_mul_f32 v72, v32, v72
    v_mul_f32 v73, v33, v73
    v_mfma_f32_16x16x32_bf16 v[96:99], v[200:203], a[216:219], v[96:99]
    ds_read_b64_tr_b16 v[216:217], v6 offset:16384
    v_cvt_pk_bf16_f32 v240, v72, v73
    v_mfma_f32_16x16x32_bf16 v[96:99], v[204:207], a[236:239], v[96:99]
    ds_read_b64_tr_b16 v[218:219], v6 offset:16896
    v_mfma_f32_16x16x32_bf16 v[100:103], v[200:203], a[220:223], v[100:103]
    ds_read_b64_tr_b16 v[220:221], v6 offset:17408
    v_mfma_f32_16x16x32_bf16 v[100:103], v[204:207], a[240:243], v[100:103]
    ds_read_b64_tr_b16 v[222:223], v6 offset:17920
    v_mfma_f32_16x16x32_bf16 v[104:107], v[200:203], a[224:227], v[104:107]
    ds_read_b64_tr_b16 v[224:225], v6 offset:18432
    v_mfma_f32_16x16x32_bf16 v[104:107], v[204:207], a[244:247], v[104:107]
    ds_read_b64_tr_b16 v[226:227], v6 offset:18944
    v_mfma_f32_16x16x32_bf16 v[108:111], v[200:203], a[228:231], v[108:111]
    ds_read_b64_tr_b16 v[228:229], v6 offset:19456
    v_mfma_f32_16x16x32_bf16 v[108:111], v[204:207], a[248:251], v[108:111]
    ds_read_b64_tr_b16 v[230:231], v6 offset:19968
    v_mfma_f32_16x16x32_bf16 v[112:115], v[200:203], a[232:235], v[112:115]
    v_rcp_f32 v34, v234
    v_mfma_f32_16x16x32_bf16 v[112:115], v[204:207], a[252:255], v[112:115]
    v_rcp_f32 v35, v235
    v_mfma_f32_16x16x32_bf16 v[136:139], v[208:211], a[216:219], v[136:139]
    v_mul_f32 v74, v34, v74
    v_mul_f32 v75, v35, v75
    v_mfma_f32_16x16x32_bf16 v[136:139], v[212:215], a[236:239], v[136:139]
    v_rcp_f32 v52, v236
    v_mfma_f32_16x16x32_bf16 v[140:143], v[208:211], a[220:223], v[140:143]
    v_rcp_f32 v53, v237
    v_mfma_f32_16x16x32_bf16 v[140:143], v[212:215], a[240:243], v[140:143]
    v_mul_f32 v92, v52, v92
    v_cvt_pk_bf16_f32 v241, v74, v75
    v_mfma_f32_16x16x32_bf16 v[144:147], v[208:211], a[224:227], v[144:147]
    v_rcp_f32 v54, v238
    v_mfma_f32_16x16x32_bf16 v[144:147], v[212:215], a[244:247], v[144:147]
    v_mul_f32 v93, v53, v93
    v_mul_f32 v94, v54, v94
    v_mfma_f32_16x16x32_bf16 v[148:151], v[208:211], a[228:231], v[148:151]
    v_rcp_f32 v55, v239
    v_mfma_f32_16x16x32_bf16 v[148:151], v[212:215], a[248:251], v[148:151]
    v_cvt_pk_bf16_f32 v242, v92, v93
    v_mul_f32 v95, v55, v95
    v_mfma_f32_16x16x32_bf16 v[152:155], v[208:211], a[232:235], v[152:155]
    v_cvt_pk_bf16_f32 v243, v94, v95
    v_mfma_f32_16x16x32_bf16 v[152:155], v[212:215], a[252:255], v[152:155]
    s_waitcnt lgkmcnt(0)
    s_barrier
    buffer_store_dwordx4 v[240:243], v9, s[24:27], s87 offen offset:0 sc1
    v_mfma_f32_16x16x32_bf16 v[116:119], v[216:219], a[216:219], v[116:119]
    s_add_u32 m0, s77, 16384
    v_mfma_f32_16x16x32_bf16 v[116:119], v[220:223], a[236:239], v[116:119]
    buffer_load_dwordx4 v7, s[16:19], 0 offen offset:0 lds
    v_mfma_f32_16x16x32_bf16 v[120:123], v[216:219], a[220:223], v[120:123]
    v_mfma_f32_16x16x32_bf16 v[120:123], v[220:223], a[240:243], v[120:123]
    v_mfma_f32_16x16x32_bf16 v[124:127], v[216:219], a[224:227], v[124:127]
    buffer_load_dwordx4 v7, s[16:19], s84 offen offset:1024 lds
    v_mfma_f32_16x16x32_bf16 v[124:127], v[220:223], a[244:247], v[124:127]
    v_mfma_f32_16x16x32_bf16 v[128:131], v[216:219], a[228:231], v[128:131]
    v_mfma_f32_16x16x32_bf16 v[128:131], v[220:223], a[248:251], v[128:131]
    v_mfma_f32_16x16x32_bf16 v[132:135], v[216:219], a[232:235], v[132:135]
    buffer_load_dwordx4 v7, s[16:19], s85 offen offset:2048 lds
    v_mfma_f32_16x16x32_bf16 v[132:135], v[220:223], a[252:255], v[132:135]
    v_mfma_f32_16x16x32_bf16 v[156:159], v[224:227], a[216:219], v[156:159]
    v_mfma_f32_16x16x32_bf16 v[156:159], v[228:231], a[236:239], v[156:159]
    s_cmp_eq_u32 s100, 2
    s_cselect_b32 s91, s101, 114688
    v_mfma_f32_16x16x32_bf16 v[160:163], v[224:227], a[220:223], v[160:163]
    buffer_load_dwordx4 v7, s[16:19], s86 offen offset:3072 lds
    v_mfma_f32_16x16x32_bf16 v[160:163], v[228:231], a[240:243], v[160:163]
    v_add_u32 v7, s91, v7
    v_mfma_f32_16x16x32_bf16 v[164:167], v[224:227], a[224:227], v[164:167]
    v_mfma_f32_16x16x32_bf16 v[164:167], v[228:231], a[244:247], v[164:167]
    v_mfma_f32_16x16x32_bf16 v[168:171], v[224:227], a[228:231], v[168:171]
    v_mfma_f32_16x16x32_bf16 v[168:171], v[228:231], a[248:251], v[168:171]
    v_mfma_f32_16x16x32_bf16 v[172:175], v[224:227], a[232:235], v[172:175]
    v_mfma_f32_16x16x32_bf16 v[172:175], v[228:231], a[252:255], v[172:175]
    s_add_u32 s87, s87, 266240
    v_pk_mul_f32 v[232:233], v[96:97], s[48:49]
    v_pk_mul_f32 v[234:235], v[98:99], s[48:49]
    v_pk_mul_f32 v[236:237], v[116:117], s[48:49]
    v_pk_mul_f32 v[238:239], v[118:119], s[48:49]
    v_exp_f32 v232, v232
    v_pk_mul_f32 v[136:137], v[96:97], v[136:137]
    v_exp_f32 v233, v233
    ds_read_b64_tr_b16 a[0:1], v176 offset:0
    ds_read_b64_tr_b16 a[2:3], v176 offset:2048
    ds_read_b64_tr_b16 a[4:5], v177 offset:0
    ds_read_b64_tr_b16 a[6:7], v177 offset:2048
    ds_read_b64_tr_b16 a[8:9], v178 offset:0
    ds_read_b64_tr_b16 a[10:11], v178 offset:2048
    ds_read_b64_tr_b16 a[12:13], v179 offset:0
    ds_read_b64_tr_b16 a[14:15], v179 offset:2048
    v_exp_f32 v234, v234
    v_pk_mul_f32 v[138:139], v[98:99], v[138:139]
    v_exp_f32 v235, v235
    v_exp_f32 v236, v236
    v_pk_mul_f32 v[156:157], v[116:117], v[156:157]
    v_exp_f32 v237, v237
    v_exp_f32 v238, v238
    v_pk_mul_f32 v[158:159], v[118:119], v[158:159]
    v_exp_f32 v239, v239
    v_pk_add_f32 v[232:233], v[232:233], s[50:51]
    v_pk_add_f32 v[234:235], v[234:235], s[50:51]
    v_pk_add_f32 v[236:237], v[236:237], s[50:51]
    v_pk_add_f32 v[238:239], v[238:239], s[50:51]
    v_rcp_f32 v96, v232
    v_rcp_f32 v97, v233
    v_rcp_f32 v98, v234
    v_rcp_f32 v99, v235
    v_pk_mul_f32 v[136:137], v[96:97], v[136:137]
    v_rcp_f32 v116, v236
    v_rcp_f32 v117, v237
    v_pk_mul_f32 v[138:139], v[98:99], v[138:139]
    v_cvt_pk_bf16_f32 v240, v136, v137
    v_rcp_f32 v118, v238
    v_rcp_f32 v119, v239
    v_pk_mul_f32 v[156:157], v[116:117], v[156:157]
    v_cvt_pk_bf16_f32 v241, v138, v139
    v_cvt_pk_bf16_f32 v242, v156, v157
    v_pk_mul_f32 v[158:159], v[118:119], v[158:159]
    ds_read_b64_tr_b16 a[16:17], v176 offset:4096
    ds_read_b64_tr_b16 a[18:19], v176 offset:6144
    ds_read_b64_tr_b16 a[20:21], v177 offset:4096
    ds_read_b64_tr_b16 a[22:23], v177 offset:6144
    ds_read_b64_tr_b16 a[24:25], v178 offset:4096
    ds_read_b64_tr_b16 a[26:27], v178 offset:6144
    ds_read_b64_tr_b16 a[28:29], v179 offset:4096
    ds_read_b64_tr_b16 a[30:31], v179 offset:6144
    v_cvt_pk_bf16_f32 v243, v158, v159
    buffer_store_dwordx4 v[240:243], v8, s[24:27], s87 offen offset:0 sc1
    v_pk_mul_f32 v[232:233], v[100:101], s[48:49]
    v_pk_mul_f32 v[234:235], v[102:103], s[48:49]
    v_pk_mul_f32 v[236:237], v[120:121], s[48:49]
    v_pk_mul_f32 v[238:239], v[122:123], s[48:49]
    v_exp_f32 v232, v232
    v_pk_mul_f32 v[140:141], v[100:101], v[140:141]
    v_exp_f32 v233, v233
    v_exp_f32 v234, v234
    v_pk_mul_f32 v[142:143], v[102:103], v[142:143]
    v_exp_f32 v235, v235
    v_exp_f32 v236, v236
    v_pk_mul_f32 v[160:161], v[120:121], v[160:161]
    v_exp_f32 v237, v237
    v_exp_f32 v238, v238
    v_pk_mul_f32 v[162:163], v[122:123], v[162:163]
    v_exp_f32 v239, v239
    v_pk_add_f32 v[232:233], v[232:233], s[50:51]
    v_pk_add_f32 v[234:235], v[234:235], s[50:51]
    v_pk_add_f32 v[236:237], v[236:237], s[50:51]
    v_pk_add_f32 v[238:239], v[238:239], s[50:51]
    v_rcp_f32 v100, v232
    v_rcp_f32 v101, v233
    s_waitcnt lgkmcnt(8)
    v_rcp_f32 v102, v234
    v_rcp_f32 v103, v235
    v_pk_mul_f32 v[140:141], v[100:101], v[140:141]
    s_add_u32 m0, s76, 0
    v_rcp_f32 v120, v236
    v_rcp_f32 v121, v237
    v_pk_mul_f32 v[142:143], v[102:103], v[142:143]
    v_cvt_pk_bf16_f32 v244, v140, v141
    buffer_load_dwordx4 v7, s[16:19], 0 offen offset:0 lds
    v_rcp_f32 v122, v238
    v_rcp_f32 v123, v239
    v_pk_mul_f32 v[160:161], v[120:121], v[160:161]
    buffer_load_dwordx4 v7, s[16:19], s84 offen offset:1024 lds
    v_cvt_pk_bf16_f32 v245, v142, v143
    v_cvt_pk_bf16_f32 v246, v160, v161
    v_pk_mul_f32 v[162:163], v[122:123], v[162:163]
    buffer_load_dwordx4 v7, s[16:19], s85 offen offset:2048 lds
    v_cvt_pk_bf16_f32 v247, v162, v163
    buffer_store_dwordx4 v[244:247], v8, s[24:27], s87 offen offset:1024 sc1
    s_waitcnt vmcnt(9)
    v_cmp_ne_u32 vcc, 1, v14
    s_nop 1
    s_cbranch_vccz CK1
    s_mov_b32 s92, 0
SP2:
    buffer_load_dword v14, v15, s[32:35], 0 offen offset:0 sc1
    s_waitcnt vmcnt(0)
    v_cmp_ne_u32 vcc, 1, v14
    s_nop 1
    s_cbranch_vccz SD3
    s_add_u32 s92, s92, 1
    s_cmp_lt_u32 s92, 0x40000
    s_sleep 1
    s_cbranch_scc1 SP2
SD3:
CK1:
    buffer_atomic_add v11, v10, s[24:27], 0 offen
    buffer_load_dwordx4 v7, s[16:19], s86 offen offset:3072 lds
    v_pk_mul_f32 v[232:233], v[104:105], s[48:49]
    v_pk_mul_f32 v[234:235], v[106:107], s[48:49]
    v_pk_mul_f32 v[236:237], v[124:125], s[48:49]
    s_cmp_eq_u32 s100, 3
    s_cselect_b32 s91, s101, 114688
    v_pk_mul_f32 v[238:239], v[126:127], s[48:49]
    v_exp_f32 v232, v232
    v_pk_mul_f32 v[144:145], v[104:105], v[144:145]
    v_add_u32 v7, s91, v7
    v_exp_f32 v233, v233
    v_exp_f32 v234, v234
    v_pk_mul_f32 v[146:147], v[106:107], v[146:147]
    v_exp_f32 v235, v235
    v_exp_f32 v236, v236
    v_pk_mul_f32 v[164:165], v[124:125], v[164:165]
    ds_read_b64_tr_b16 a[32:33], v176 offset:8192
    ds_read_b64_tr_b16 a[34:35], v176 offset:10240
    ds_read_b64_tr_b16 a[36:37], v177 offset:8192
    ds_read_b64_tr_b16 a[38:39], v177 offset:10240
    ds_read_b64_tr_b16 a[40:41], v178 offset:8192
    ds_read_b64_tr_b16 a[42:43], v178 offset:10240
    ds_read_b64_tr_b16 a[44:45], v179 offset:8192
    ds_read_b64_tr_b16 a[46:47], v179 offset:10240
    v_exp_f32 v237, v237
    v_exp_f32 v238, v238
    v_pk_mul_f32 v[166:167], v[126:127], v[166:167]
    v_exp_f32 v239, v239
    v_pk_add_f32 v[232:233], v[232:233], s[50:51]
    v_pk_add_f32 v[234:235], v[234:235], s[50:51]
    v_pk_add_f32 v[236:237], v[236:237], s[50:51]
    v_pk_add_f32 v[238:239], v[238:239], s[50:51]
    v_rcp_f32 v104, v232
    v_rcp_f32 v105, v233
    v_rcp_f32 v106, v234
    v_rcp_f32 v107, v235
    v_pk_mul_f32 v[144:145], v[104:105], v[144:145]
    v_rcp_f32 v124, v236
    v_rcp_f32 v125, v237
    v_pk_mul_f32 v[146:147], v[106:107], v[146:147]
    v_cvt_pk_bf16_f32 v240, v144, v145
    v_rcp_f32 v126, v238
    v_rcp_f32 v127, v239
    v_pk_mul_f32 v[164:165], v[124:125], v[164:165]
    v_cvt_pk_bf16_f32 v241, v146, v147
    v_cvt_pk_bf16_f32 v242, v164, v165
    v_pk_mul_f32 v[166:167], v[126:127], v[166:167]
    v_cvt_pk_bf16_f32 v243, v166, v167
    buffer_store_dwordx4 v[240:243], v8, s[24:27], s87 offen offset:2048 sc1
    s_waitcnt lgkmcnt(8)
    v_pk_mul_f32 v[232:233], v[108:109], s[48:49]
    v_pk_mul_f32 v[234:235], v[110:111], s[48:49]
    v_pk_mul_f32 v[236:237], v[128:129], s[48:49]
    s_add_u32 m0, s76, 4096
    v_pk_mul_f32 v[238:239], v[130:131], s[48:49]
    v_exp_f32 v232, v232
    v_pk_mul_f32 v[148:149], v[108:109], v[148:149]
    buffer_load_dwordx4 v7, s[16:19], 0 offen offset:0 lds
    v_exp_f32 v233, v233
    v_exp_f32 v234, v234
    v_pk_mul_f32 v[150:151], v[110:111], v[150:151]
    buffer_load_dwordx4 v7, s[16:19], s84 offen offset:1024 lds
    v_exp_f32 v235, v235
    v_exp_f32 v236, v236
    v_pk_mul_f32 v[168:169], v[128:129], v[168:169]
    buffer_load_dwordx4 v7, s[16:19], s85 offen offset:2048 lds
    v_exp_f32 v237, v237
    v_exp_f32 v238, v238
    v_pk_mul_f32 v[170:171], v[130:131], v[170:171]
    v_exp_f32 v239, v239
    buffer_load_dwordx4 v7, s[16:19], s86 offen offset:3072 lds
    v_pk_add_f32 v[232:233], v[232:233], s[50:51]
    v_pk_add_f32 v[234:235], v[234:235], s[50:51]
    v_pk_add_f32 v[236:237], v[236:237], s[50:51]
    s_cmp_eq_u32 s100, 4
    s_cselect_b32 s91, s101, 114688
    v_pk_add_f32 v[238:239], v[238:239], s[50:51]
    v_rcp_f32 v108, v232
    v_rcp_f32 v109, v233
    v_add_u32 v7, s91, v7
    v_rcp_f32 v110, v234
    v_rcp_f32 v111, v235
    v_pk_mul_f32 v[148:149], v[108:109], v[148:149]
    v_rcp_f32 v128, v236
    v_rcp_f32 v129, v237
    v_pk_mul_f32 v[150:151], v[110:111], v[150:151]
    ds_read_b64_tr_b16 a[48:49], v176 offset:12288
    ds_read_b64_tr_b16 a[50:51], v176 offset:14336
    ds_read_b64_tr_b16 a[52:53], v177 offset:12288
    ds_read_b64_tr_b16 a[54:55], v177 offset:14336
    ds_read_b64_tr_b16 a[56:57], v178 offset:12288
    ds_read_b64_tr_b16 a[58:59], v178 offset:14336
    ds_read_b64_tr_b16 a[60:61], v179 offset:12288
    ds_read_b64_tr_b16 a[62:63], v179 offset:14336
    v_cvt_pk_bf16_f32 v244, v148, v149
    v_rcp_f32 v130, v238
    v_rcp_f32 v131, v239
    v_pk_mul_f32 v[168:169], v[128:129], v[168:169]
    v_cvt_pk_bf16_f32 v245, v150, v151
    v_cvt_pk_bf16_f32 v246, v168, v169
    v_pk_mul_f32 v[170:171], v[130:131], v[170:171]
    v_cvt_pk_bf16_f32 v247, v170, v171
    buffer_store_dwordx4 v[244:247], v8, s[24:27], s87 offen offset:3072 sc1
    v_pk_mul_f32 v[232:233], v[112:113], s[48:49]
    v_pk_mul_f32 v[234:235], v[114:115], s[48:49]
    v_pk_mul_f32 v[236:237], v[132:133], s[48:49]
    v_pk_mul_f32 v[238:239], v[134:135], s[48:49]
    v_exp_f32 v232, v232
    v_pk_mul_f32 v[152:153], v[112:113], v[152:153]
    v_exp_f32 v233, v233
    v_exp_f32 v234, v234
    v_pk_mul_f32 v[154:155], v[114:115], v[154:155]
    v_exp_f32 v235, v235
    v_exp_f32 v236, v236
    v_pk_mul_f32 v[172:173], v[132:133], v[172:173]
    v_exp_f32 v237, v237
    v_exp_f32 v238, v238
    v_pk_mul_f32 v[174:175], v[134:135], v[174:175]
    v_exp_f32 v239, v239
    s_waitcnt lgkmcnt(8)
    v_pk_add_f32 v[232:233], v[232:233], s[50:51]
    v_pk_add_f32 v[234:235], v[234:235], s[50:51]
    v_pk_add_f32 v[236:237], v[236:237], s[50:51]
    s_add_u32 m0, s76, 8192
    v_pk_add_f32 v[238:239], v[238:239], s[50:51]
    v_rcp_f32 v112, v232
    v_rcp_f32 v113, v233
    buffer_load_dwordx4 v7, s[16:19], 0 offen offset:0 lds
    v_rcp_f32 v114, v234
    v_rcp_f32 v115, v235
    v_pk_mul_f32 v[152:153], v[112:113], v[152:153]
    buffer_load_dwordx4 v7, s[16:19], s84 offen offset:1024 lds
    v_rcp_f32 v132, v236
    v_rcp_f32 v133, v237
    v_pk_mul_f32 v[154:155], v[114:115], v[154:155]
    buffer_load_dwordx4 v7, s[16:19], s85 offen offset:2048 lds
    v_cvt_pk_bf16_f32 v240, v152, v153
    v_rcp_f32 v134, v238
    v_rcp_f32 v135, v239
    buffer_load_dwordx4 v7, s[16:19], s86 offen offset:3072 lds
    v_pk_mul_f32 v[172:173], v[132:133], v[172:173]
    v_cvt_pk_bf16_f32 v241, v154, v155
    v_cvt_pk_bf16_f32 v242, v172, v173
    s_cmp_eq_u32 s100, 5
    s_cselect_b32 s91, s101, 114688
    v_pk_mul_f32 v[174:175], v[134:135], v[174:175]
    v_cvt_pk_bf16_f32 v243, v174, v175
    buffer_store_dwordx4 v[240:243], v9, s[24:27], s87 offen offset:0 sc1
    v_add_u32 v7, s91, v7
    ds_read_b64_tr_b16 a[64:65], v176 offset:16384
    ds_read_b64_tr_b16 a[66:67], v176 offset:18432
    ds_read_b64_tr_b16 a[68:69], v177 offset:16384
    ds_read_b64_tr_b16 a[70:71], v177 offset:18432
    ds_read_b64_tr_b16 a[72:73], v178 offset:16384
    ds_read_b64_tr_b16 a[74:75], v178 offset:18432
    ds_read_b64_tr_b16 a[76:77], v179 offset:16384
    ds_read_b64_tr_b16 a[78:79], v179 offset:18432
    s_waitcnt lgkmcnt(8)
    s_add_u32 m0, s76, 12288
    s_nop 0
    buffer_load_dwordx4 v7, s[16:19], 0 offen offset:0 lds
    buffer_load_dwordx4 v7, s[16:19], s84 offen offset:1024 lds
    buffer_load_dwordx4 v7, s[16:19], s85 offen offset:2048 lds
    buffer_load_dwordx4 v7, s[16:19], s86 offen offset:3072 lds
    v_mov_b32 v7, v248
    ds_read_b64_tr_b16 a[80:81], v176 offset:20480
    ds_read_b64_tr_b16 a[82:83], v176 offset:22528
    ds_read_b64_tr_b16 a[84:85], v177 offset:20480
    ds_read_b64_tr_b16 a[86:87], v177 offset:22528
    ds_read_b64_tr_b16 a[88:89], v178 offset:20480
    ds_read_b64_tr_b16 a[90:91], v178 offset:22528
    ds_read_b64_tr_b16 a[92:93], v179 offset:20480
    ds_read_b64_tr_b16 a[94:95], v179 offset:22528
    s_waitcnt lgkmcnt(8)
    s_add_u32 m0, s76, 16384
    s_nop 0
    buffer_load_dwordx4 v7, s[20:23], 0 offen offset:0 lds
    buffer_load_dwordx4 v7, s[20:23], s84 offen offset:1024 lds
    buffer_load_dwordx4 v7, s[20:23], s85 offen offset:2048 lds
    buffer_load_dwordx4 v7, s[20:23], s86 offen offset:3072 lds
    s_cmp_eq_u32 s38, 0
    s_cselect_b32 s91, s36, 25088
    v_add_u32 v7, s91, v7
    s_waitcnt vmcnt(8)
    buffer_atomic_add v11, v10, s[24:27], 0 offen offset:512
    ds_read_b64_tr_b16 a[96:97], v180 offset:32768
    ds_read_b64_tr_b16 a[98:99], v180 offset:34816
    ds_read_b64_tr_b16 a[100:101], v181 offset:32768
    ds_read_b64_tr_b16 a[102:103], v181 offset:34816
    ds_read_b64_tr_b16 a[104:105], v182 offset:32768
    ds_read_b64_tr_b16 a[106:107], v182 offset:34816
    ds_read_b64_tr_b16 a[108:109], v183 offset:32768
    ds_read_b64_tr_b16 a[110:111], v183 offset:34816
    s_waitcnt lgkmcnt(8)
    buffer_load_dword v12, v13, s[24:27], 0 offen offset:0 sc1
    s_add_u32 m0, s76, 20480
    s_nop 0
    buffer_load_dwordx4 v7, s[20:23], 0 offen offset:0 lds
    buffer_load_dwordx4 v7, s[20:23], s84 offen offset:1024 lds
    buffer_load_dwordx4 v7, s[20:23], s85 offen offset:2048 lds
    buffer_load_dwordx4 v7, s[20:23], s86 offen offset:3072 lds
    s_cmp_eq_u32 s38, 1
    s_cselect_b32 s91, s36, 25088
    v_add_u32 v7, s91, v7
    ds_read_b64_tr_b16 a[112:113], v180 offset:49152
    ds_read_b64_tr_b16 a[114:115], v180 offset:51200
    ds_read_b64_tr_b16 a[116:117], v181 offset:49152
    ds_read_b64_tr_b16 a[118:119], v181 offset:51200
    ds_read_b64_tr_b16 a[120:121], v182 offset:49152
    ds_read_b64_tr_b16 a[122:123], v182 offset:51200
    ds_read_b64_tr_b16 a[124:125], v183 offset:49152
    ds_read_b64_tr_b16 a[126:127], v183 offset:51200
    s_waitcnt lgkmcnt(8)
    s_add_u32 m0, s77, 32768
    s_nop 0
    buffer_load_dwordx4 v7, s[20:23], 0 offen offset:0 lds
    buffer_load_dwordx4 v7, s[20:23], s84 offen offset:1024 lds
    buffer_load_dwordx4 v7, s[20:23], s85 offen offset:2048 lds
    buffer_load_dwordx4 v7, s[20:23], s86 offen offset:3072 lds
    s_cmp_eq_u32 s38, 2
    s_cselect_b32 s91, s36, 25088
    v_add_u32 v7, s91, v7
    s_waitcnt lgkmcnt(0)
    s_add_u32 m0, s77, 49152
    s_nop 0
    buffer_load_dwordx4 v7, s[20:23], 0 offen offset:0 lds
    buffer_load_dwordx4 v7, s[20:23], s84 offen offset:1024 lds
    buffer_load_dwordx4 v7, s[20:23], s85 offen offset:2048 lds
    buffer_load_dwordx4 v7, s[20:23], s86 offen offset:3072 lds
    s_waitcnt vmcnt(12)
    v_cmp_ne_u32 vcc, 7, v12
    s_nop 1
    s_cbranch_vccz CK4
    s_mov_b32 s92, 0
SP5:
    buffer_load_dword v12, v13, s[24:27], 0 offen offset:0 sc1
    s_waitcnt vmcnt(0)
    v_cmp_ne_u32 vcc, 7, v12
    s_nop 1
    s_cbranch_vccz SD6
    s_add_u32 s92, s92, 1
    s_cmp_lt_u32 s92, 0x40000
    s_sleep 1
    s_cbranch_scc1 SP5
SD6:
CK4:
    s_mov_b32 s44, s88
    s_cmp_eq_u32 s100, 0
    s_cselect_b32 s91, s3, 532480
    s_add_u32 s88, s88, s91
    s_mov_b32 s45, s88
    s_cmp_eq_u32 s100, 1
    s_cselect_b32 s91, s3, 532480
    s_add_u32 s88, s88, s91
    buffer_load_dwordx4 a[128:131], v8, s[24:27], s44 offen offset:0 sc1
    buffer_load_dwordx4 a[148:151], v8, s[24:27], s45 offen offset:0 sc1
    buffer_load_dwordx4 a[132:135], v8, s[24:27], s44 offen offset:1024 sc1
    buffer_load_dwordx4 a[152:155], v8, s[24:27], s45 offen offset:1024 sc1
    buffer_load_dwordx4 a[136:139], v8, s[24:27], s44 offen offset:2048 sc1
    buffer_load_dwordx4 a[156:159], v8, s[24:27], s45 offen offset:2048 sc1
    buffer_load_dwordx4 a[140:143], v251, s[24:27], s44 offen offset:3072 sc1
    buffer_load_dwordx4 a[160:163], v251, s[24:27], s45 offen offset:3072 sc1
    buffer_load_dwordx4 a[144:147], v252, s[24:27], s44 offen offset:0 sc1
    buffer_load_dwordx4 a[164:167], v252, s[24:27], s45 offen offset:0 sc1
    s_mov_b32 s44, s88
    s_cmp_eq_u32 s100, 2
    s_cselect_b32 s91, s3, 532480
    s_add_u32 s88, s88, s91
    s_mov_b32 s45, s88
    s_cmp_eq_u32 s100, 3
    s_cselect_b32 s91, s3, 532480
    s_add_u32 s88, s88, s91
    s_waitcnt vmcnt(8) lgkmcnt(0)
    v_mfma_f32_16x16x32_bf16 v[16:19], a[0:3], a[128:131], 0
    buffer_load_dwordx4 a[168:171], v8, s[24:27], s44 offen offset:0 sc1
    v_mfma_f32_16x16x32_bf16 v[16:19], a[16:19], a[148:151], v[16:19]
    v_mfma_f32_16x16x32_bf16 v[36:39], a[4:7], a[128:131], 0
    v_mfma_f32_16x16x32_bf16 v[36:39], a[20:23], a[148:151], v[36:39]
    v_mfma_f32_16x16x32_bf16 v[56:59], a[8:11], a[128:131], 0
    buffer_load_dwordx4 a[188:191], v8, s[24:27], s45 offen offset:0 sc1
    v_mfma_f32_16x16x32_bf16 v[56:59], a[24:27], a[148:151], v[56:59]
    v_mfma_f32_16x16x32_bf16 v[76:79], a[12:15], a[128:131], 0
    v_mfma_f32_16x16x32_bf16 v[76:79], a[28:31], a[148:151], v[76:79]
    s_waitcnt vmcnt(8)
    v_mfma_f32_16x16x32_bf16 v[20:23], a[0:3], a[132:135], 0
    buffer_load_dwordx4 a[172:175], v8, s[24:27], s44 offen offset:1024 sc1
    v_mfma_f32_16x16x32_bf16 v[20:23], a[16:19], a[152:155], v[20:23]
    v_mfma_f32_16x16x32_bf16 v[40:43], a[4:7], a[132:135], 0
    v_mfma_f32_16x16x32_bf16 v[40:43], a[20:23], a[152:155], v[40:43]
    v_mfma_f32_16x16x32_bf16 v[60:63], a[8:11], a[132:135], 0
    buffer_load_dwordx4 a[192:195], v8, s[24:27], s45 offen offset:1024 sc1
    v_mfma_f32_16x16x32_bf16 v[60:63], a[24:27], a[152:155], v[60:63]
    v_mfma_f32_16x16x32_bf16 v[80:83], a[12:15], a[132:135], 0
    v_mfma_f32_16x16x32_bf16 v[80:83], a[28:31], a[152:155], v[80:83]
    s_waitcnt vmcnt(8)
    v_mfma_f32_16x16x32_bf16 v[24:27], a[0:3], a[136:139], 0
    buffer_load_dwordx4 a[176:179], v8, s[24:27], s44 offen offset:2048 sc1
    v_mfma_f32_16x16x32_bf16 v[24:27], a[16:19], a[156:159], v[24:27]
    v_mfma_f32_16x16x32_bf16 v[44:47], a[4:7], a[136:139], 0
    v_mfma_f32_16x16x32_bf16 v[44:47], a[20:23], a[156:159], v[44:47]
    v_mfma_f32_16x16x32_bf16 v[64:67], a[8:11], a[136:139], 0
    buffer_load_dwordx4 a[196:199], v8, s[24:27], s45 offen offset:2048 sc1
    v_mfma_f32_16x16x32_bf16 v[64:67], a[24:27], a[156:159], v[64:67]
    v_mfma_f32_16x16x32_bf16 v[84:87], a[12:15], a[136:139], 0
    v_mfma_f32_16x16x32_bf16 v[84:87], a[28:31], a[156:159], v[84:87]
    s_waitcnt vmcnt(8)
    v_mfma_f32_16x16x32_bf16 v[28:31], a[0:3], a[140:143], 0
    buffer_load_dwordx4 a[180:183], v251, s[24:27], s44 offen offset:3072 sc1
    v_mfma_f32_16x16x32_bf16 v[28:31], a[16:19], a[160:163], v[28:31]
    v_mfma_f32_16x16x32_bf16 v[48:51], a[4:7], a[140:143], 0
    v_mfma_f32_16x16x32_bf16 v[48:51], a[20:23], a[160:163], v[48:51]
    v_mfma_f32_16x16x32_bf16 v[68:71], a[8:11], a[140:143], 0
    buffer_load_dwordx4 a[200:203], v251, s[24:27], s45 offen offset:3072 sc1
    v_mfma_f32_16x16x32_bf16 v[68:71], a[24:27], a[160:163], v[68:71]
    v_mfma_f32_16x16x32_bf16 v[88:91], a[12:15], a[140:143], 0
    v_mfma_f32_16x16x32_bf16 v[88:91], a[28:31], a[160:163], v[88:91]
    s_waitcnt vmcnt(8)
    v_mfma_f32_16x16x32_bf16 v[32:35], a[0:3], a[144:147], 0
    buffer_load_dwordx4 a[184:187], v252, s[24:27], s44 offen offset:0 sc1
    v_mfma_f32_16x16x32_bf16 v[32:35], a[16:19], a[164:167], v[32:35]
    v_mfma_f32_16x16x32_bf16 v[52:55], a[4:7], a[144:147], 0
    v_mfma_f32_16x16x32_bf16 v[52:55], a[20:23], a[164:167], v[52:55]
    v_mfma_f32_16x16x32_bf16 v[72:75], a[8:11], a[144:147], 0
    buffer_load_dwordx4 a[204:207], v252, s[24:27], s45 offen offset:0 sc1
    v_mfma_f32_16x16x32_bf16 v[72:75], a[24:27], a[164:167], v[72:75]
    s_mov_b32 s44, s88
    v_mfma_f32_16x16x32_bf16 v[92:95], a[12:15], a[144:147], 0
    s_cmp_eq_u32 s100, 4
    s_cselect_b32 s91, s3, 532480
    s_add_u32 s88, s88, s91
    v_mfma_f32_16x16x32_bf16 v[92:95], a[28:31], a[164:167], v[92:95]
    s_waitcnt vmcnt(8) lgkmcnt(0)
    s_mov_b32 s45, s88
    s_cmp_eq_u32 s100, 5
    s_cselect_b32 s91, s3, 532480
    s_add_u32 s88, s88, s91
    v_mfma_f32_16x16x32_bf16 v[16:19], a[32:35], a[168:171], v[16:19]
    buffer_load_dwordx4 a[208:211], v8, s[24:27], s44 offen offset:0 sc1
    v_mfma_f32_16x16x32_bf16 v[16:19], a[48:51], a[188:191], v[16:19]
    v_mfma_f32_16x16x32_bf16 v[36:39], a[36:39], a[168:171], v[36:39]
    v_mfma_f32_16x16x32_bf16 v[36:39], a[52:55], a[188:191], v[36:39]
    v_mfma_f32_16x16x32_bf16 v[56:59], a[40:43], a[168:171], v[56:59]
    buffer_load_dwordx4 a[228:231], v8, s[24:27], s45 offen offset:0 sc1
    v_mfma_f32_16x16x32_bf16 v[56:59], a[56:59], a[188:191], v[56:59]
    v_mfma_f32_16x16x32_bf16 v[76:79], a[44:47], a[168:171], v[76:79]
    v_mfma_f32_16x16x32_bf16 v[76:79], a[60:63], a[188:191], v[76:79]
    s_waitcnt vmcnt(8)
    v_mfma_f32_16x16x32_bf16 v[20:23], a[32:35], a[172:175], v[20:23]
    buffer_load_dwordx4 a[212:215], v8, s[24:27], s44 offen offset:1024 sc1
    v_mfma_f32_16x16x32_bf16 v[20:23], a[48:51], a[192:195], v[20:23]
    v_mfma_f32_16x16x32_bf16 v[40:43], a[36:39], a[172:175], v[40:43]
    v_mfma_f32_16x16x32_bf16 v[40:43], a[52:55], a[192:195], v[40:43]
    v_mfma_f32_16x16x32_bf16 v[60:63], a[40:43], a[172:175], v[60:63]
    buffer_load_dwordx4 a[232:235], v8, s[24:27], s45 offen offset:1024 sc1
    v_mfma_f32_16x16x32_bf16 v[60:63], a[56:59], a[192:195], v[60:63]
    v_mfma_f32_16x16x32_bf16 v[80:83], a[44:47], a[172:175], v[80:83]
    v_mfma_f32_16x16x32_bf16 v[80:83], a[60:63], a[192:195], v[80:83]
    s_waitcnt vmcnt(8)
    v_mfma_f32_16x16x32_bf16 v[24:27], a[32:35], a[176:179], v[24:27]
    buffer_load_dwordx4 a[216:219], v8, s[24:27], s44 offen offset:2048 sc1
    v_mfma_f32_16x16x32_bf16 v[24:27], a[48:51], a[196:199], v[24:27]
    v_mfma_f32_16x16x32_bf16 v[44:47], a[36:39], a[176:179], v[44:47]
    buffer_load_dword v12, v13, s[24:27], 0 offen offset:512 sc1
    v_mfma_f32_16x16x32_bf16 v[44:47], a[52:55], a[196:199], v[44:47]
    v_mfma_f32_16x16x32_bf16 v[64:67], a[40:43], a[176:179], v[64:67]
    buffer_load_dwordx4 a[236:239], v8, s[24:27], s45 offen offset:2048 sc1
    v_mfma_f32_16x16x32_bf16 v[64:67], a[56:59], a[196:199], v[64:67]
    v_mfma_f32_16x16x32_bf16 v[84:87], a[44:47], a[176:179], v[84:87]
    v_mfma_f32_16x16x32_bf16 v[84:87], a[60:63], a[196:199], v[84:87]
    s_waitcnt vmcnt(9)
    v_mfma_f32_16x16x32_bf16 v[28:31], a[32:35], a[180:183], v[28:31]
    buffer_load_dwordx4 a[220:223], v251, s[24:27], s44 offen offset:3072 sc1
    v_mfma_f32_16x16x32_bf16 v[28:31], a[48:51], a[200:203], v[28:31]
    v_mfma_f32_16x16x32_bf16 v[48:51], a[36:39], a[180:183], v[48:51]
    v_mfma_f32_16x16x32_bf16 v[48:51], a[52:55], a[200:203], v[48:51]
    v_mfma_f32_16x16x32_bf16 v[68:71], a[40:43], a[180:183], v[68:71]
    buffer_load_dwordx4 a[240:243], v251, s[24:27], s45 offen offset:3072 sc1
    v_mfma_f32_16x16x32_bf16 v[68:71], a[56:59], a[200:203], v[68:71]
    v_mfma_f32_16x16x32_bf16 v[88:91], a[44:47], a[180:183], v[88:91]
    v_mfma_f32_16x16x32_bf16 v[88:91], a[60:63], a[200:203], v[88:91]
    s_waitcnt vmcnt(9)
    v_mfma_f32_16x16x32_bf16 v[32:35], a[32:35], a[184:187], v[32:35]
    buffer_load_dwordx4 a[224:227], v252, s[24:27], s44 offen offset:0 sc1
    v_mfma_f32_16x16x32_bf16 v[32:35], a[48:51], a[204:207], v[32:35]
    v_mfma_f32_16x16x32_bf16 v[52:55], a[36:39], a[184:187], v[52:55]
    v_mfma_f32_16x16x32_bf16 v[52:55], a[52:55], a[204:207], v[52:55]
    v_mfma_f32_16x16x32_bf16 v[72:75], a[40:43], a[184:187], v[72:75]
    buffer_load_dwordx4 a[244:247], v252, s[24:27], s45 offen offset:0 sc1
    v_mfma_f32_16x16x32_bf16 v[72:75], a[56:59], a[204:207], v[72:75]
    s_mov_b32 s44, s88
    v_mfma_f32_16x16x32_bf16 v[92:95], a[44:47], a[184:187], v[92:95]
    s_cmp_eq_u32 s100, 6
    s_cselect_b32 s91, s3, 532480
    s_add_u32 s88, s88, s91
    v_mfma_f32_16x16x32_bf16 v[92:95], a[60:63], a[204:207], v[92:95]
    s_waitcnt vmcnt(9) lgkmcnt(0)
    s_add_u32 s88, s88, 266240
    v_mfma_f32_16x16x32_bf16 v[16:19], a[64:67], a[208:211], v[16:19]
    buffer_load_dwordx4 v[96:99], v8, s[24:27], s44 offen offset:0 sc1
    v_mfma_f32_16x16x32_bf16 v[16:19], a[80:83], a[228:231], v[16:19]
    v_mfma_f32_16x16x32_bf16 v[36:39], a[68:71], a[208:211], v[36:39]
    v_mfma_f32_16x16x32_bf16 v[36:39], a[84:87], a[228:231], v[36:39]
    v_mfma_f32_16x16x32_bf16 v[56:59], a[72:75], a[208:211], v[56:59]
    buffer_load_dwordx4 v[100:103], v8, s[24:27], s44 offen offset:1024 sc1
    v_mfma_f32_16x16x32_bf16 v[56:59], a[88:91], a[228:231], v[56:59]
    v_mfma_f32_16x16x32_bf16 v[76:79], a[76:79], a[208:211], v[76:79]
    v_mfma_f32_16x16x32_bf16 v[76:79], a[92:95], a[228:231], v[76:79]
    s_waitcnt vmcnt(9)
    v_mfma_f32_16x16x32_bf16 v[20:23], a[64:67], a[212:215], v[20:23]
    buffer_load_dwordx4 v[104:107], v8, s[24:27], s44 offen offset:2048 sc1
    v_mfma_f32_16x16x32_bf16 v[20:23], a[80:83], a[232:235], v[20:23]
    v_mfma_f32_16x16x32_bf16 v[40:43], a[68:71], a[212:215], v[40:43]
    v_mfma_f32_16x16x32_bf16 v[40:43], a[84:87], a[232:235], v[40:43]
    v_mfma_f32_16x16x32_bf16 v[60:63], a[72:75], a[212:215], v[60:63]
    buffer_load_dwordx4 v[108:111], v251, s[24:27], s44 offen offset:3072 sc1
    v_mfma_f32_16x16x32_bf16 v[60:63], a[88:91], a[232:235], v[60:63]
    v_mfma_f32_16x16x32_bf16 v[80:83], a[76:79], a[212:215], v[80:83]
    v_mfma_f32_16x16x32_bf16 v[80:83], a[92:95], a[232:235], v[80:83]
    s_waitcnt vmcnt(8)
    v_cmp_ne_u32 vcc, 7, v12
    s_nop 1
    s_cbranch_vccz CK7
    s_mov_b32 s92, 0
SP8:
    buffer_load_dword v12, v13, s[24:27], 0 offen offset:512 sc1
    s_waitcnt vmcnt(0)
    v_cmp_ne_u32 vcc, 7, v12
    s_nop 1
    s_cbranch_vccz SD9
    s_add_u32 s92, s92, 1
    s_cmp_lt_u32 s92, 0x40000
    s_sleep 1
    s_cbranch_scc1 SP8
SD9:
CK7:
    v_mfma_f32_16x16x32_bf16 v[24:27], a[64:67], a[216:219], v[24:27]
    buffer_load_dwordx4 v[112:115], v252, s[24:27], s44 offen offset:0 sc1
    v_mfma_f32_16x16x32_bf16 v[24:27], a[80:83], a[236:239], v[24:27]
    s_mov_b32 s44, s88
    v_mfma_f32_16x16x32_bf16 v[44:47], a[68:71], a[216:219], v[44:47]
    s_cmp_eq_u32 s100, 0
    s_cselect_b32 s91, s3, 532480
    s_add_u32 s88, s88, s91
    v_mfma_f32_16x16x32_bf16 v[44:47], a[84:87], a[236:239], v[44:47]
    s_mov_b32 s45, s88
    v_mfma_f32_16x16x32_bf16 v[64:67], a[72:75], a[216:219], v[64:67]
    s_cmp_eq_u32 s100, 1
    s_cselect_b32 s91, s3, 532480
    s_add_u32 s88, s88, s91
    v_mfma_f32_16x16x32_bf16 v[64:67], a[88:91], a[236:239], v[64:67]
    buffer_load_dwordx4 v[116:119], v8, s[24:27], s44 offen offset:0 sc1
    v_mfma_f32_16x16x32_bf16 v[84:87], a[76:79], a[216:219], v[84:87]
    v_mfma_f32_16x16x32_bf16 v[84:87], a[92:95], a[236:239], v[84:87]
    s_waitcnt vmcnt(8)
    v_mfma_f32_16x16x32_bf16 v[28:31], a[64:67], a[220:223], v[28:31]
    buffer_load_dwordx4 v[136:139], v8, s[24:27], s45 offen offset:0 sc1
    v_mfma_f32_16x16x32_bf16 v[28:31], a[80:83], a[240:243], v[28:31]
    v_mfma_f32_16x16x32_bf16 v[48:51], a[68:71], a[220:223], v[48:51]
    v_mfma_f32_16x16x32_bf16 v[48:51], a[84:87], a[240:243], v[48:51]
    v_mfma_f32_16x16x32_bf16 v[68:71], a[72:75], a[220:223], v[68:71]
    buffer_load_dwordx4 v[120:123], v8, s[24:27], s44 offen offset:1024 sc1
    v_mfma_f32_16x16x32_bf16 v[68:71], a[88:91], a[240:243], v[68:71]
    v_mfma_f32_16x16x32_bf16 v[88:91], a[76:79], a[220:223], v[88:91]
    v_mfma_f32_16x16x32_bf16 v[88:91], a[92:95], a[240:243], v[88:91]
    s_waitcnt vmcnt(8)
    v_mfma_f32_16x16x32_bf16 v[32:35], a[64:67], a[224:227], v[32:35]
    buffer_load_dwordx4 v[140:143], v8, s[24:27], s45 offen offset:1024 sc1
    v_mfma_f32_16x16x32_bf16 v[32:35], a[80:83], a[244:247], v[32:35]
    v_mfma_f32_16x16x32_bf16 v[52:55], a[68:71], a[224:227], v[52:55]
    v_mfma_f32_16x16x32_bf16 v[52:55], a[84:87], a[244:247], v[52:55]
    v_mfma_f32_16x16x32_bf16 v[72:75], a[72:75], a[224:227], v[72:75]
    buffer_load_dwordx4 v[124:127], v8, s[24:27], s44 offen offset:2048 sc1
    v_mfma_f32_16x16x32_bf16 v[72:75], a[88:91], a[244:247], v[72:75]
    v_mfma_f32_16x16x32_bf16 v[92:95], a[76:79], a[224:227], v[92:95]
    v_mfma_f32_16x16x32_bf16 v[92:95], a[92:95], a[244:247], v[92:95]
    s_waitcnt vmcnt(9) lgkmcnt(0)
    v_mfma_f32_16x16x32_bf16 v[16:19], a[96:99], v[96:99], v[16:19]
    buffer_load_dwordx4 v[144:147], v8, s[24:27], s45 offen offset:2048 sc1
    ds_read_b64_tr_b16 a[0:1], v180 offset:0
    v_mfma_f32_16x16x32_bf16 v[36:39], a[100:103], v[96:99], v[36:39]
    ds_read_b64_tr_b16 a[2:3], v180 offset:2048
    v_mfma_f32_16x16x32_bf16 v[56:59], a[104:107], v[96:99], v[56:59]
    v_mfma_f32_16x16x32_bf16 v[76:79], a[108:111], v[96:99], v[76:79]
    s_waitcnt vmcnt(9)
    v_mfma_f32_16x16x32_bf16 v[20:23], a[96:99], v[100:103], v[20:23]
    buffer_load_dwordx4 v[128:131], v251, s[24:27], s44 offen offset:3072 sc1
    ds_read_b64_tr_b16 a[4:5], v181 offset:0
    v_mfma_f32_16x16x32_bf16 v[40:43], a[100:103], v[100:103], v[40:43]
    ds_read_b64_tr_b16 a[6:7], v181 offset:2048
    v_mfma_f32_16x16x32_bf16 v[60:63], a[104:107], v[100:103], v[60:63]
    v_mfma_f32_16x16x32_bf16 v[80:83], a[108:111], v[100:103], v[80:83]
    s_waitcnt vmcnt(9)
    v_mfma_f32_16x16x32_bf16 v[24:27], a[96:99], v[104:107], v[24:27]
    buffer_load_dwordx4 v[148:151], v251, s[24:27], s45 offen offset:3072 sc1
    ds_read_b64_tr_b16 a[8:9], v182 offset:0
    v_mfma_f32_16x16x32_bf16 v[44:47], a[100:103], v[104:107], v[44:47]
    ds_read_b64_tr_b16 a[10:11], v182 offset:2048
    v_mfma_f32_16x16x32_bf16 v[64:67], a[104:107], v[104:107], v[64:67]
    v_mfma_f32_16x16x32_bf16 v[84:87], a[108:111], v[104:107], v[84:87]
    s_waitcnt vmcnt(9)
    v_mfma_f32_16x16x32_bf16 v[28:31], a[96:99], v[108:111], v[28:31]
    buffer_load_dwordx4 v[132:135], v252, s[24:27], s44 offen offset:0 sc1
    ds_read_b64_tr_b16 a[12:13], v183 offset:0
    v_mfma_f32_16x16x32_bf16 v[48:51], a[100:103], v[108:111], v[48:51]
    ds_read_b64_tr_b16 a[14:15], v183 offset:2048
    v_mfma_f32_16x16x32_bf16 v[68:71], a[104:107], v[108:111], v[68:71]
    v_mfma_f32_16x16x32_bf16 v[88:91], a[108:111], v[108:111], v[88:91]
    s_waitcnt vmcnt(9)
    v_mfma_f32_16x16x32_bf16 v[32:35], a[96:99], v[112:115], v[32:35]
    buffer_load_dwordx4 v[152:155], v252, s[24:27], s45 offen offset:0 sc1
    v_mfma_f32_16x16x32_bf16 v[52:55], a[100:103], v[112:115], v[52:55]
    s_mov_b32 s44, s88
    v_mfma_f32_16x16x32_bf16 v[72:75], a[104:107], v[112:115], v[72:75]
    s_cmp_eq_u32 s100, 2
    s_cselect_b32 s91, s3, 532480
    s_add_u32 s88, s88, s91
    v_mfma_f32_16x16x32_bf16 v[92:95], a[108:111], v[112:115], v[92:95]
    s_waitcnt vmcnt(8) lgkmcnt(0)
    s_mov_b32 s45, s88
    s_cmp_eq_u32 s100, 3
    s_cselect_b32 s91, s3, 532480
    s_add_u32 s88, s88, s91
    v_mfma_f32_16x16x32_bf16 v[16:19], a[112:115], v[116:119], v[16:19]
    buffer_load_dwordx4 v[156:159], v8, s[24:27], s44 offen offset:0 sc1
    v_mfma_f32_16x16x32_bf16 v[16:19], a[0:3], v[136:139], v[16:19]
    v_mfma_f32_16x16x32_bf16 v[36:39], a[116:119], v[116:119], v[36:39]
    v_mfma_f32_16x16x32_bf16 v[36:39], a[4:7], v[136:139], v[36:39]
    v_mfma_f32_16x16x32_bf16 v[56:59], a[120:123], v[116:119], v[56:59]
    buffer_load_dwordx4 a[128:131], v8, s[24:27], s45 offen offset:0 sc1
    v_mfma_f32_16x16x32_bf16 v[56:59], a[8:11], v[136:139], v[56:59]
    v_mfma_f32_16x16x32_bf16 v[76:79], a[124:127], v[116:119], v[76:79]
    v_mfma_f32_16x16x32_bf16 v[76:79], a[12:15], v[136:139], v[76:79]
    s_waitcnt vmcnt(8)
    v_mfma_f32_16x16x32_bf16 v[20:23], a[112:115], v[120:123], v[20:23]
    buffer_load_dwordx4 v[160:163], v8, s[24:27], s44 offen offset:1024 sc1
    ds_read_b64_tr_b16 a[16:17], v180 offset:16384
    v_mfma_f32_16x16x32_bf16 v[20:23], a[0:3], v[140:143], v[20:23]
    ds_read_b64_tr_b16 a[18:19], v180 offset:18432
    v_mfma_f32_16x16x32_bf16 v[40:43], a[116:119], v[120:123], v[40:43]
    ds_read_b64_tr_b16 a[20:21], v181 offset:16384
    v_mfma_f32_16x16x32_bf16 v[40:43], a[4:7], v[140:143], v[40:43]
    v_mfma_f32_16x16x32_bf16 v[60:63], a[120:123], v[120:123], v[60:63]
    buffer_load_dwordx4 a[132:135], v8, s[24:27], s45 offen offset:1024 sc1
    ds_read_b64_tr_b16 a[22:23], v181 offset:18432
    v_mfma_f32_16x16x32_bf16 v[60:63], a[8:11], v[140:143], v[60:63]
    ds_read_b64_tr_b16 a[24:25], v182 offset:16384
    v_mfma_f32_16x16x32_bf16 v[80:83], a[124:127], v[120:123], v[80:83]
    v_mfma_f32_16x16x32_bf16 v[80:83], a[12:15], v[140:143], v[80:83]
    s_waitcnt vmcnt(8)
    v_mfma_f32_16x16x32_bf16 v[24:27], a[112:115], v[124:127], v[24:27]
    buffer_load_dwordx4 v[164:167], v8, s[24:27], s44 offen offset:2048 sc1
    ds_read_b64_tr_b16 a[26:27], v182 offset:18432
    v_mfma_f32_16x16x32_bf16 v[24:27], a[0:3], v[144:147], v[24:27]
    ds_read_b64_tr_b16 a[28:29], v183 offset:16384
    v_mfma_f32_16x16x32_bf16 v[44:47], a[116:119], v[124:127], v[44:47]
    v_mfma_f32_16x16x32_bf16 v[44:47], a[4:7], v[144:147], v[44:47]
    v_mfma_f32_16x16x32_bf16 v[64:67], a[120:123], v[124:127], v[64:67]
    buffer_load_dwordx4 a[136:139], v8, s[24:27], s45 offen offset:2048 sc1
    ds_read_b64_tr_b16 a[30:31], v183 offset:18432
    v_mfma_f32_16x16x32_bf16 v[64:67], a[8:11], v[144:147], v[64:67]
    ds_read_b64_tr_b16 a[32:33], v176 offset:0
    v_mfma_f32_16x16x32_bf16 v[84:87], a[124:127], v[124:127], v[84:87]
    ds_read_b64_tr_b16 a[34:35], v176 offset:2048
    v_mfma_f32_16x16x32_bf16 v[84:87], a[12:15], v[144:147], v[84:87]
    s_waitcnt vmcnt(8)
    v_mfma_f32_16x16x32_bf16 v[28:31], a[112:115], v[128:131], v[28:31]
    buffer_load_dwordx4 v[168:171], v251, s[24:27], s44 offen offset:3072 sc1
    ds_read_b64_tr_b16 a[36:37], v177 offset:0
    v_mfma_f32_16x16x32_bf16 v[28:31], a[0:3], v[148:151], v[28:31]
    ds_read_b64_tr_b16 a[38:39], v177 offset:2048
    v_mfma_f32_16x16x32_bf16 v[48:51], a[116:119], v[128:131], v[48:51]
    v_mfma_f32_16x16x32_bf16 v[48:51], a[4:7], v[148:151], v[48:51]
    v_mfma_f32_16x16x32_bf16 v[68:71], a[120:123], v[128:131], v[68:71]
    buffer_load_dwordx4 a[140:143], v251, s[24:27], s45 offen offset:3072 sc1
    ds_read_b64_tr_b16 a[40:41], v178 offset:0
    v_mfma_f32_16x16x32_bf16 v[68:71], a[8:11], v[148:151], v[68:71]
    ds_read_b64_tr_b16 a[42:43], v178 offset:2048
    v_mfma_f32_16x16x32_bf16 v[88:91], a[124:127], v[128:131], v[88:91]
    v_mfma_f32_16x16x32_bf16 v[88:91], a[12:15], v[148:151], v[88:91]
    s_waitcnt vmcnt(8)
    v_mfma_f32_16x16x32_bf16 v[32:35], a[112:115], v[132:135], v[32:35]
    buffer_load_dwordx4 v[172:175], v252, s[24:27], s44 offen offset:0 sc1
    ds_read_b64_tr_b16 a[44:45], v179 offset:0
    v_mfma_f32_16x16x32_bf16 v[32:35], a[0:3], v[152:155], v[32:35]
    ds_read_b64_tr_b16 a[46:47], v179 offset:2048
    v_mfma_f32_16x16x32_bf16 v[52:55], a[116:119], v[132:135], v[52:55]
    v_mfma_f32_16x16x32_bf16 v[52:55], a[4:7], v[152:155], v[52:55]
    v_mfma_f32_16x16x32_bf16 v[72:75], a[120:123], v[132:135], v[72:75]
    buffer_load_dwordx4 a[144:147], v252, s[24:27], s45 offen offset:0 sc1
    v_mfma_f32_16x16x32_bf16 v[72:75], a[8:11], v[152:155], v[72:75]
    s_mov_b32 s44, s88
    v_mfma_f32_16x16x32_bf16 v[92:95], a[124:127], v[132:135], v[92:95]
    s_cmp_eq_u32 s100, 4
    s_cselect_b32 s91, s3, 532480
    s_add_u32 s88, s88, s91
    v_mfma_f32_16x16x32_bf16 v[92:95], a[12:15], v[152:155], v[92:95]
    s_waitcnt vmcnt(8) lgkmcnt(0)
    s_mov_b32 s45, s88
    s_cmp_eq_u32 s100, 5
    s_cselect_b32 s91, s3, 532480
    s_add_u32 s88, s88, s91
    v_mfma_f32_16x16x32_bf16 v[16:19], a[16:19], v[156:159], v[16:19]
    buffer_load_dwordx4 a[148:151], v8, s[24:27], s44 offen offset:0 sc1
    v_mfma_f32_16x16x32_bf16 v[16:19], a[32:35], a[128:131], v[16:19]
    v_mfma_f32_16x16x32_bf16 v[36:39], a[20:23], v[156:159], v[36:39]
    v_mfma_f32_16x16x32_bf16 v[36:39], a[36:39], a[128:131], v[36:39]
    v_mfma_f32_16x16x32_bf16 v[56:59], a[24:27], v[156:159], v[56:59]
    buffer_load_dwordx4 a[168:171], v8, s[24:27], s45 offen offset:0 sc1
    v_mfma_f32_16x16x32_bf16 v[56:59], a[40:43], a[128:131], v[56:59]
    v_mfma_f32_16x16x32_bf16 v[76:79], a[28:31], v[156:159], v[76:79]
    v_mfma_f32_16x16x32_bf16 v[76:79], a[44:47], a[128:131], v[76:79]
    s_waitcnt vmcnt(8)
    v_mfma_f32_16x16x32_bf16 v[20:23], a[16:19], v[160:163], v[20:23]
    buffer_load_dwordx4 a[152:155], v8, s[24:27], s44 offen offset:1024 sc1
    ds_read_b64_tr_b16 a[48:49], v176 offset:4096
    v_mfma_f32_16x16x32_bf16 v[20:23], a[32:35], a[132:135], v[20:23]
    ds_read_b64_tr_b16 a[50:51], v176 offset:6144
    v_mfma_f32_16x16x32_bf16 v[40:43], a[20:23], v[160:163], v[40:43]
    ds_read_b64_tr_b16 a[52:53], v177 offset:4096
    v_mfma_f32_16x16x32_bf16 v[40:43], a[36:39], a[132:135], v[40:43]
    v_mfma_f32_16x16x32_bf16 v[60:63], a[24:27], v[160:163], v[60:63]
    buffer_load_dwordx4 a[172:175], v8, s[24:27], s45 offen offset:1024 sc1
    ds_read_b64_tr_b16 a[54:55], v177 offset:6144
    v_mfma_f32_16x16x32_bf16 v[60:63], a[40:43], a[132:135], v[60:63]
    ds_read_b64_tr_b16 a[56:57], v178 offset:4096
    v_mfma_f32_16x16x32_bf16 v[80:83], a[28:31], v[160:163], v[80:83]
    v_mfma_f32_16x16x32_bf16 v[80:83], a[44:47], a[132:135], v[80:83]
    s_waitcnt vmcnt(8)
    v_mfma_f32_16x16x32_bf16 v[24:27], a[16:19], v[164:167], v[24:27]
    buffer_load_dwordx4 a[156:159], v8, s[24:27], s44 offen offset:2048 sc1
    ds_read_b64_tr_b16 a[58:59], v178 offset:6144
    v_mfma_f32_16x16x32_bf16 v[24:27], a[32:35], a[136:139], v[24:27]
    ds_read_b64_tr_b16 a[60:61], v179 offset:4096
    v_mfma_f32_16x16x32_bf16 v[44:47], a[20:23], v[164:167], v[44:47]
    buffer_load_dword v12, v187, s[24:27], 0 offen offset:0 sc1
    v_mfma_f32_16x16x32_bf16 v[44:47], a[36:39], a[136:139], v[44:47]
    v_mfma_f32_16x16x32_bf16 v[64:67], a[24:27], v[164:167], v[64:67]
    buffer_load_dwordx4 a[176:179], v8, s[24:27], s45 offen offset:2048 sc1
    ds_read_b64_tr_b16 a[62:63], v179 offset:6144
    v_mfma_f32_16x16x32_bf16 v[64:67], a[40:43], a[136:139], v[64:67]
    ds_read_b64_tr_b16 a[64:65], v176 offset:8192
    v_mfma_f32_16x16x32_bf16 v[84:87], a[28:31], v[164:167], v[84:87]
    ds_read_b64_tr_b16 a[66:67], v176 offset:10240
    v_mfma_f32_16x16x32_bf16 v[84:87], a[44:47], a[136:139], v[84:87]
    s_waitcnt vmcnt(9)
    v_mfma_f32_16x16x32_bf16 v[28:31], a[16:19], v[168:171], v[28:31]
    buffer_load_dwordx4 a[160:163], v251, s[24:27], s44 offen offset:3072 sc1
    ds_read_b64_tr_b16 a[68:69], v177 offset:8192
    v_mfma_f32_16x16x32_bf16 v[28:31], a[32:35], a[140:143], v[28:31]
    ds_read_b64_tr_b16 a[70:71], v177 offset:10240
    v_mfma_f32_16x16x32_bf16 v[48:51], a[20:23], v[168:171], v[48:51]
    v_mfma_f32_16x16x32_bf16 v[48:51], a[36:39], a[140:143], v[48:51]
    v_mfma_f32_16x16x32_bf16 v[68:71], a[24:27], v[168:171], v[68:71]
    buffer_load_dwordx4 a[180:183], v251, s[24:27], s45 offen offset:3072 sc1
    ds_read_b64_tr_b16 a[72:73], v178 offset:8192
    v_mfma_f32_16x16x32_bf16 v[68:71], a[40:43], a[140:143], v[68:71]
    ds_read_b64_tr_b16 a[74:75], v178 offset:10240
    v_mfma_f32_16x16x32_bf16 v[88:91], a[28:31], v[168:171], v[88:91]
    v_mfma_f32_16x16x32_bf16 v[88:91], a[44:47], a[140:143], v[88:91]
    s_waitcnt vmcnt(9)
    v_mfma_f32_16x16x32_bf16 v[32:35], a[16:19], v[172:175], v[32:35]
    buffer_load_dwordx4 a[164:167], v252, s[24:27], s44 offen offset:0 sc1
    ds_read_b64_tr_b16 a[76:77], v179 offset:8192
    v_mfma_f32_16x16x32_bf16 v[32:35], a[32:35], a[144:147], v[32:35]
    ds_read_b64_tr_b16 a[78:79], v179 offset:10240
    v_mfma_f32_16x16x32_bf16 v[52:55], a[20:23], v[172:175], v[52:55]
    v_mfma_f32_16x16x32_bf16 v[52:55], a[36:39], a[144:147], v[52:55]
    v_mfma_f32_16x16x32_bf16 v[72:75], a[24:27], v[172:175], v[72:75]
    buffer_load_dwordx4 a[184:187], v252, s[24:27], s45 offen offset:0 sc1
    v_mfma_f32_16x16x32_bf16 v[72:75], a[40:43], a[144:147], v[72:75]
    s_mov_b32 s44, s88
    s_mov_b32 s88, s71
    v_mfma_f32_16x16x32_bf16 v[92:95], a[28:31], v[172:175], v[92:95]
    v_mfma_f32_16x16x32_bf16 v[92:95], a[44:47], a[144:147], v[92:95]
    s_waitcnt vmcnt(9) lgkmcnt(0)
    v_mfma_f32_16x16x32_bf16 v[16:19], a[48:51], a[148:151], v[16:19]
    buffer_load_dwordx4 a[188:191], v8, s[24:27], s44 offen offset:0 sc1
    v_mfma_f32_16x16x32_bf16 v[16:19], a[64:67], a[168:171], v[16:19]
    v_mfma_f32_16x16x32_bf16 v[36:39], a[52:55], a[148:151], v[36:39]
    v_mfma_f32_16x16x32_bf16 v[36:39], a[68:71], a[168:171], v[36:39]
    v_mfma_f32_16x16x32_bf16 v[56:59], a[56:59], a[148:151], v[56:59]
    buffer_load_dwordx4 a[192:195], v8, s[24:27], s44 offen offset:1024 sc1
    v_mfma_f32_16x16x32_bf16 v[56:59], a[72:75], a[168:171], v[56:59]
    v_mfma_f32_16x16x32_bf16 v[76:79], a[60:63], a[148:151], v[76:79]
    v_mfma_f32_16x16x32_bf16 v[76:79], a[76:79], a[168:171], v[76:79]
    s_waitcnt vmcnt(9)
    v_mfma_f32_16x16x32_bf16 v[20:23], a[48:51], a[152:155], v[20:23]
    buffer_load_dwordx4 a[196:199], v8, s[24:27], s44 offen offset:2048 sc1
    v_mfma_f32_16x16x32_bf16 v[20:23], a[64:67], a[172:175], v[20:23]
    v_mfma_f32_16x16x32_bf16 v[40:43], a[52:55], a[152:155], v[40:43]
    v_mfma_f32_16x16x32_bf16 v[40:43], a[68:71], a[172:175], v[40:43]
    v_mfma_f32_16x16x32_bf16 v[60:63], a[56:59], a[152:155], v[60:63]
    buffer_load_dwordx4 a[200:203], v251, s[24:27], s44 offen offset:3072 sc1
    v_mfma_f32_16x16x32_bf16 v[60:63], a[72:75], a[172:175], v[60:63]
    v_mfma_f32_16x16x32_bf16 v[80:83], a[60:63], a[152:155], v[80:83]
    v_mfma_f32_16x16x32_bf16 v[80:83], a[76:79], a[172:175], v[80:83]
    s_waitcnt vmcnt(8)
    v_cmp_ne_u32 vcc, 4, v12
    s_nop 1
    s_cbranch_vccz CK10
    s_mov_b32 s92, 0
SP11:
    buffer_load_dword v12, v187, s[24:27], 0 offen offset:0 sc1
    s_waitcnt vmcnt(0)
    v_cmp_ne_u32 vcc, 4, v12
    s_nop 1
    s_cbranch_vccz SD12
    s_add_u32 s92, s92, 1
    s_cmp_lt_u32 s92, 0x40000
    s_sleep 1
    s_cbranch_scc1 SP11
SD12:
CK10:
    v_mfma_f32_16x16x32_bf16 v[24:27], a[48:51], a[156:159], v[24:27]
    buffer_load_dwordx4 a[204:207], v252, s[24:27], s44 offen offset:0 sc1
    v_mfma_f32_16x16x32_bf16 v[24:27], a[64:67], a[176:179], v[24:27]
    s_mov_b32 s44, s88
    v_mfma_f32_16x16x32_bf16 v[44:47], a[52:55], a[156:159], v[44:47]
    s_cmp_eq_u32 s38, 0
    s_cselect_b32 s91, s37, 133120
    s_add_u32 s88, s88, s91
    v_mfma_f32_16x16x32_bf16 v[44:47], a[68:71], a[176:179], v[44:47]
    v_mfma_f32_16x16x32_bf16 v[64:67], a[56:59], a[156:159], v[64:67]
    buffer_load_dwordx4 a[208:211], v8, s[24:27], s44 offen offset:0 sc1
    ds_read_b64_tr_b16 a[80:81], v176 offset:12288
    v_mfma_f32_16x16x32_bf16 v[64:67], a[72:75], a[176:179], v[64:67]
    ds_read_b64_tr_b16 a[82:83], v176 offset:14336
    v_mfma_f32_16x16x32_bf16 v[84:87], a[60:63], a[156:159], v[84:87]
    v_mfma_f32_16x16x32_bf16 v[84:87], a[76:79], a[176:179], v[84:87]
    s_waitcnt vmcnt(8)
    v_mfma_f32_16x16x32_bf16 v[28:31], a[48:51], a[160:163], v[28:31]
    buffer_load_dwordx4 a[212:215], v8, s[24:27], s44 offen offset:1024 sc1
    ds_read_b64_tr_b16 a[84:85], v177 offset:12288
    v_mfma_f32_16x16x32_bf16 v[28:31], a[64:67], a[180:183], v[28:31]
    ds_read_b64_tr_b16 a[86:87], v177 offset:14336
    v_mfma_f32_16x16x32_bf16 v[48:51], a[52:55], a[160:163], v[48:51]
    v_mfma_f32_16x16x32_bf16 v[48:51], a[68:71], a[180:183], v[48:51]
    v_mfma_f32_16x16x32_bf16 v[68:71], a[56:59], a[160:163], v[68:71]
    buffer_load_dwordx4 a[216:219], v8, s[24:27], s44 offen offset:2048 sc1
    ds_read_b64_tr_b16 a[88:89], v178 offset:12288
    v_mfma_f32_16x16x32_bf16 v[68:71], a[72:75], a[180:183], v[68:71]
    ds_read_b64_tr_b16 a[90:91], v178 offset:14336
    v_mfma_f32_16x16x32_bf16 v[88:91], a[60:63], a[160:163], v[88:91]
    v_mfma_f32_16x16x32_bf16 v[88:91], a[76:79], a[180:183], v[88:91]
    s_waitcnt vmcnt(8)
    v_mfma_f32_16x16x32_bf16 v[32:35], a[48:51], a[164:167], v[32:35]
    buffer_load_dwordx4 a[220:223], v251, s[24:27], s44 offen offset:3072 sc1
    ds_read_b64_tr_b16 a[92:93], v179 offset:12288
    v_mfma_f32_16x16x32_bf16 v[32:35], a[64:67], a[184:187], v[32:35]
    ds_read_b64_tr_b16 a[94:95], v179 offset:14336
    v_mfma_f32_16x16x32_bf16 v[52:55], a[52:55], a[164:167], v[52:55]
    ds_read_b64_tr_b16 a[112:113], v176 offset:20480
    v_mfma_f32_16x16x32_bf16 v[52:55], a[68:71], a[184:187], v[52:55]
    ds_read_b64_tr_b16 a[114:115], v176 offset:22528
    v_mfma_f32_16x16x32_bf16 v[72:75], a[56:59], a[164:167], v[72:75]
    buffer_load_dwordx4 a[224:227], v252, s[24:27], s44 offen offset:0 sc1
    ds_read_b64_tr_b16 a[116:117], v177 offset:20480
    v_mfma_f32_16x16x32_bf16 v[72:75], a[72:75], a[184:187], v[72:75]
    s_mov_b32 s44, s88
    ds_read_b64_tr_b16 a[118:119], v177 offset:22528
    v_mfma_f32_16x16x32_bf16 v[92:95], a[60:63], a[164:167], v[92:95]
    s_cmp_eq_u32 s38, 1
    s_cselect_b32 s91, s37, 133120
    s_add_u32 s88, s88, s91
    v_mfma_f32_16x16x32_bf16 v[92:95], a[76:79], a[184:187], v[92:95]
    s_mov_b32 s45, s88
    s_cmp_eq_u32 s38, 2
    s_cselect_b32 s91, s37, 133120
    s_add_u32 s88, s88, s91
    s_mov_b32 s46, s88
    ds_read_b64_tr_b16 a[120:121], v178 offset:20480
    s_waitcnt vmcnt(9) lgkmcnt(0)
    v_mfma_f32_16x16x32_bf16 v[16:19], a[80:83], a[188:191], v[16:19]
    buffer_load_dwordx4 a[228:231], v8, s[24:27], s44 offen offset:0 sc1
    ds_read_b64_tr_b16 a[96:97], v176 offset:16384
    v_mfma_f32_16x16x32_bf16 v[36:39], a[84:87], a[188:191], v[36:39]
    ds_read_b64_tr_b16 a[98:99], v176 offset:18432
    v_mfma_f32_16x16x32_bf16 v[56:59], a[88:91], a[188:191], v[56:59]
    ds_read_b64_tr_b16 a[122:123], v178 offset:22528
    v_mfma_f32_16x16x32_bf16 v[76:79], a[92:95], a[188:191], v[76:79]
    ds_read_b64_tr_b16 a[124:125], v179 offset:20480
    s_waitcnt vmcnt(9)
    v_mfma_f32_16x16x32_bf16 v[20:23], a[80:83], a[192:195], v[20:23]
    buffer_load_dwordx4 v[96:99], v8, s[24:27], s45 offen offset:0 sc1
    ds_read_b64_tr_b16 a[100:101], v177 offset:16384
    v_mfma_f32_16x16x32_bf16 v[40:43], a[84:87], a[192:195], v[40:43]
    ds_read_b64_tr_b16 a[102:103], v177 offset:18432
    v_mfma_f32_16x16x32_bf16 v[60:63], a[88:91], a[192:195], v[60:63]
    ds_read_b64_tr_b16 a[126:127], v179 offset:22528
    v_mfma_f32_16x16x32_bf16 v[80:83], a[92:95], a[192:195], v[80:83]
    ds_read_b64_tr_b16 a[0:1], v180 offset:32768
    s_waitcnt vmcnt(9)
    v_mfma_f32_16x16x32_bf16 v[24:27], a[80:83], a[196:199], v[24:27]
    buffer_load_dwordx4 v[116:119], v8, s[24:27], s46 offen offset:0 sc1
    ds_read_b64_tr_b16 a[104:105], v178 offset:16384
    v_mfma_f32_16x16x32_bf16 v[44:47], a[84:87], a[196:199], v[44:47]
    ds_read_b64_tr_b16 a[106:107], v178 offset:18432
    v_mfma_f32_16x16x32_bf16 v[64:67], a[88:91], a[196:199], v[64:67]
    ds_read_b64_tr_b16 a[2:3], v180 offset:34816
    v_mfma_f32_16x16x32_bf16 v[84:87], a[92:95], a[196:199], v[84:87]
    ds_read_b64_tr_b16 a[4:5], v181 offset:32768
    s_waitcnt vmcnt(9)
    v_mfma_f32_16x16x32_bf16 v[28:31], a[80:83], a[200:203], v[28:31]
    buffer_load_dwordx4 a[232:235], v8, s[24:27], s44 offen offset:1024 sc1
    ds_read_b64_tr_b16 a[108:109], v179 offset:16384
    v_mfma_f32_16x16x32_bf16 v[48:51], a[84:87], a[200:203], v[48:51]
    ds_read_b64_tr_b16 a[110:111], v179 offset:18432
    v_mfma_f32_16x16x32_bf16 v[68:71], a[88:91], a[200:203], v[68:71]
    ds_read_b64_tr_b16 a[6:7], v181 offset:34816
    v_mfma_f32_16x16x32_bf16 v[88:91], a[92:95], a[200:203], v[88:91]
    ds_read_b64_tr_b16 a[8:9], v182 offset:32768
    ds_read_b64_tr_b16 a[10:11], v182 offset:34816
    s_waitcnt vmcnt(9)
    v_mfma_f32_16x16x32_bf16 v[32:35], a[80:83], a[204:207], v[32:35]
    buffer_load_dwordx4 v[100:103], v8, s[24:27], s45 offen offset:1024 sc1
    ds_read_b64_tr_b16 a[12:13], v183 offset:32768
    v_mfma_f32_16x16x32_bf16 v[52:55], a[84:87], a[204:207], v[52:55]
    ds_read_b64_tr_b16 a[14:15], v183 offset:34816
    v_mfma_f32_16x16x32_bf16 v[72:75], a[88:91], a[204:207], v[72:75]
    v_mfma_f32_16x16x32_bf16 v[92:95], a[92:95], a[204:207], v[92:95]
    s_waitcnt vmcnt(9) lgkmcnt(0)
    v_mfma_f32_16x16x32_bf16 v[16:19], a[96:99], a[208:211], v[16:19]
    buffer_load_dwordx4 v[120:123], v8, s[24:27], s46 offen offset:1024 sc1
    ds_read_b64_tr_b16 a[16:17], v180 offset:49152
    v_mfma_f32_16x16x32_bf16 v[36:39], a[100:103], a[208:211], v[36:39]
    ds_read_b64_tr_b16 a[18:19], v180 offset:51200
    v_mfma_f32_16x16x32_bf16 v[56:59], a[104:107], a[208:211], v[56:59]
    v_mfma_f32_16x16x32_bf16 v[76:79], a[108:111], a[208:211], v[76:79]
    s_waitcnt vmcnt(9)
    v_mfma_f32_16x16x32_bf16 v[20:23], a[96:99], a[212:215], v[20:23]
    buffer_load_dwordx4 a[236:239], v8, s[24:27], s44 offen offset:2048 sc1
    ds_read_b64_tr_b16 a[20:21], v181 offset:49152
    v_mfma_f32_16x16x32_bf16 v[40:43], a[100:103], a[212:215], v[40:43]
    ds_read_b64_tr_b16 a[22:23], v181 offset:51200
    v_mfma_f32_16x16x32_bf16 v[60:63], a[104:107], a[212:215], v[60:63]
    v_mfma_f32_16x16x32_bf16 v[80:83], a[108:111], a[212:215], v[80:83]
    s_waitcnt vmcnt(9)
    v_mfma_f32_16x16x32_bf16 v[24:27], a[96:99], a[216:219], v[24:27]
    buffer_load_dwordx4 v[104:107], v8, s[24:27], s45 offen offset:2048 sc1
    ds_read_b64_tr_b16 a[24:25], v182 offset:49152
    v_mfma_f32_16x16x32_bf16 v[44:47], a[100:103], a[216:219], v[44:47]
    ds_read_b64_tr_b16 a[26:27], v182 offset:51200
    v_mfma_f32_16x16x32_bf16 v[64:67], a[104:107], a[216:219], v[64:67]
    v_mfma_f32_16x16x32_bf16 v[84:87], a[108:111], a[216:219], v[84:87]
    s_waitcnt vmcnt(9)
    v_mfma_f32_16x16x32_bf16 v[28:31], a[96:99], a[220:223], v[28:31]
    buffer_load_dwordx4 v[124:127], v8, s[24:27], s46 offen offset:2048 sc1
    ds_read_b64_tr_b16 a[28:29], v183 offset:49152
    v_mfma_f32_16x16x32_bf16 v[48:51], a[100:103], a[220:223], v[48:51]
    ds_read_b64_tr_b16 a[30:31], v183 offset:51200
    v_mfma_f32_16x16x32_bf16 v[68:71], a[104:107], a[220:223], v[68:71]
    v_mfma_f32_16x16x32_bf16 v[88:91], a[108:111], a[220:223], v[88:91]
    s_waitcnt vmcnt(9)
    v_mfma_f32_16x16x32_bf16 v[32:35], a[96:99], a[224:227], v[32:35]
    buffer_load_dwordx4 a[240:243], v251, s[24:27], s44 offen offset:3072 sc1
    v_mfma_f32_16x16x32_bf16 v[52:55], a[100:103], a[224:227], v[52:55]
    v_mfma_f32_16x16x32_bf16 v[72:75], a[104:107], a[224:227], v[72:75]
    v_mfma_f32_16x16x32_bf16 v[92:95], a[108:111], a[224:227], v[92:95]
    s_waitcnt vmcnt(7) lgkmcnt(0)
    v_mfma_f32_16x16x32_bf16 v[16:19], a[112:115], a[228:231], v[16:19]
    buffer_load_dwordx4 v[108:111], v251, s[24:27], s45 offen offset:3072 sc1
    v_mfma_f32_16x16x32_bf16 v[16:19], a[0:3], v[96:99], v[16:19]
    v_mfma_f32_16x16x32_bf16 v[16:19], a[16:19], v[116:119], v[16:19]
    v_mfma_f32_16x16x32_bf16 v[36:39], a[116:119], a[228:231], v[36:39]
    v_mfma_f32_16x16x32_bf16 v[36:39], a[4:7], v[96:99], v[36:39]
    buffer_load_dwordx4 v[128:131], v251, s[24:27], s46 offen offset:3072 sc1
    v_mfma_f32_16x16x32_bf16 v[36:39], a[20:23], v[116:119], v[36:39]
    v_mfma_f32_16x16x32_bf16 v[56:59], a[120:123], a[228:231], v[56:59]
    v_mfma_f32_16x16x32_bf16 v[56:59], a[8:11], v[96:99], v[56:59]
    v_mfma_f32_16x16x32_bf16 v[56:59], a[24:27], v[116:119], v[56:59]
    buffer_load_dwordx4 a[244:247], v252, s[24:27], s44 offen offset:0 sc1
    v_mfma_f32_16x16x32_bf16 v[76:79], a[124:127], a[228:231], v[76:79]
    v_mfma_f32_16x16x32_bf16 v[76:79], a[12:15], v[96:99], v[76:79]
    v_mfma_f32_16x16x32_bf16 v[76:79], a[28:31], v[116:119], v[76:79]
    s_waitcnt vmcnt(7)
    v_mfma_f32_16x16x32_bf16 v[20:23], a[112:115], a[232:235], v[20:23]
    buffer_load_dwordx4 v[112:115], v252, s[24:27], s45 offen offset:0 sc1
    v_mfma_f32_16x16x32_bf16 v[20:23], a[0:3], v[100:103], v[20:23]
    v_mfma_f32_16x16x32_bf16 v[20:23], a[16:19], v[120:123], v[20:23]
    v_mfma_f32_16x16x32_bf16 v[40:43], a[116:119], a[232:235], v[40:43]
    ds_write_b128 v190, v[36:39] offset:0
    v_mfma_f32_16x16x32_bf16 v[40:43], a[4:7], v[100:103], v[40:43]
    buffer_load_dwordx4 v[132:135], v252, s[24:27], s46 offen offset:0 sc1
    v_mfma_f32_16x16x32_bf16 v[40:43], a[20:23], v[120:123], v[40:43]
    ds_write_b128 v190, v[56:59] offset:5120
    v_mfma_f32_16x16x32_bf16 v[60:63], a[120:123], a[232:235], v[60:63]
    v_mfma_f32_16x16x32_bf16 v[60:63], a[8:11], v[100:103], v[60:63]
    v_mfma_f32_16x16x32_bf16 v[60:63], a[24:27], v[120:123], v[60:63]
    buffer_load_dword v192, v188, s[24:27], 0 offen offset:0 sc1
    ds_write_b128 v190, v[76:79] offset:10240
    v_mfma_f32_16x16x32_bf16 v[80:83], a[124:127], a[232:235], v[80:83]
    v_mfma_f32_16x16x32_bf16 v[80:83], a[12:15], v[100:103], v[80:83]
    v_mfma_f32_16x16x32_bf16 v[80:83], a[28:31], v[120:123], v[80:83]
    s_waitcnt vmcnt(7)
    v_mfma_f32_16x16x32_bf16 v[24:27], a[112:115], a[236:239], v[24:27]
    buffer_load_dword v193, v188, s[24:27], 0 offen offset:64 sc1
    v_mfma_f32_16x16x32_bf16 v[24:27], a[0:3], v[104:107], v[24:27]
    v_mfma_f32_16x16x32_bf16 v[24:27], a[16:19], v[124:127], v[24:27]
    v_mfma_f32_16x16x32_bf16 v[44:47], a[116:119], a[236:239], v[44:47]
    ds_write_b128 v190, v[40:43] offset:1024
    v_mfma_f32_16x16x32_bf16 v[44:47], a[4:7], v[104:107], v[44:47]
    buffer_load_dword v194, v188, s[24:27], 0 offen offset:128 sc1
    v_mfma_f32_16x16x32_bf16 v[44:47], a[20:23], v[124:127], v[44:47]
    ds_write_b128 v190, v[60:63] offset:6144
    v_mfma_f32_16x16x32_bf16 v[64:67], a[120:123], a[236:239], v[64:67]
    v_mfma_f32_16x16x32_bf16 v[64:67], a[8:11], v[104:107], v[64:67]
    v_or_b32 v188, s52, v188
    v_mfma_f32_16x16x32_bf16 v[64:67], a[24:27], v[124:127], v[64:67]
    buffer_load_dword v195, v188, s[24:27], 0 offen offset:192 sc1
    ds_write_b128 v190, v[80:83] offset:11264
    v_mfma_f32_16x16x32_bf16 v[84:87], a[124:127], a[236:239], v[84:87]
    v_mfma_f32_16x16x32_bf16 v[84:87], a[12:15], v[104:107], v[84:87]
    v_mfma_f32_16x16x32_bf16 v[84:87], a[28:31], v[124:127], v[84:87]
    s_waitcnt vmcnt(7)
    v_mfma_f32_16x16x32_bf16 v[28:31], a[112:115], a[240:243], v[28:31]
    buffer_load_dword v196, v188, s[24:27], 0 offen offset:256 sc1
    v_mfma_f32_16x16x32_bf16 v[28:31], a[0:3], v[108:111], v[28:31]
    v_mfma_f32_16x16x32_bf16 v[28:31], a[16:19], v[128:131], v[28:31]
    v_mfma_f32_16x16x32_bf16 v[48:51], a[116:119], a[240:243], v[48:51]
    ds_write_b128 v190, v[44:47] offset:2048
    v_mfma_f32_16x16x32_bf16 v[48:51], a[4:7], v[108:111], v[48:51]
    v_mfma_f32_16x16x32_bf16 v[48:51], a[20:23], v[128:131], v[48:51]
    ds_write_b128 v190, v[64:67] offset:7168
    v_mfma_f32_16x16x32_bf16 v[68:71], a[120:123], a[240:243], v[68:71]
    v_mfma_f32_16x16x32_bf16 v[68:71], a[8:11], v[108:111], v[68:71]
    v_mfma_f32_16x16x32_bf16 v[68:71], a[24:27], v[128:131], v[68:71]
    ds_write_b128 v190, v[84:87] offset:12288
    v_mfma_f32_16x16x32_bf16 v[88:91], a[124:127], a[240:243], v[88:91]
    v_mfma_f32_16x16x32_bf16 v[88:91], a[12:15], v[108:111], v[88:91]
    v_mfma_f32_16x16x32_bf16 v[88:91], a[28:31], v[128:131], v[88:91]
    s_waitcnt vmcnt(5)
    v_mfma_f32_16x16x32_bf16 v[32:35], a[112:115], a[244:247], v[32:35]
    v_mfma_f32_16x16x32_bf16 v[32:35], a[0:3], v[112:115], v[32:35]
    v_mfma_f32_16x16x32_bf16 v[32:35], a[16:19], v[132:135], v[32:35]
    v_mfma_f32_16x16x32_bf16 v[52:55], a[116:119], a[244:247], v[52:55]
    ds_write_b128 v190, v[48:51] offset:3072
    v_mfma_f32_16x16x32_bf16 v[52:55], a[4:7], v[112:115], v[52:55]
    v_mfma_f32_16x16x32_bf16 v[52:55], a[20:23], v[132:135], v[52:55]
    ds_write_b128 v190, v[68:71] offset:8192
    v_mfma_f32_16x16x32_bf16 v[72:75], a[120:123], a[244:247], v[72:75]
    v_mfma_f32_16x16x32_bf16 v[72:75], a[8:11], v[112:115], v[72:75]
    v_mfma_f32_16x16x32_bf16 v[72:75], a[24:27], v[132:135], v[72:75]
    ds_write_b128 v190, v[88:91] offset:13312
    v_mfma_f32_16x16x32_bf16 v[92:95], a[124:127], a[244:247], v[92:95]
    v_mfma_f32_16x16x32_bf16 v[92:95], a[12:15], v[112:115], v[92:95]
    v_mfma_f32_16x16x32_bf16 v[92:95], a[28:31], v[132:135], v[92:95]
    ds_write_b128 v190, v[52:55] offset:4096
    s_nop 2
    ds_write_b128 v190, v[72:75] offset:9216
    s_nop 2
    ds_write_b128 v190, v[92:95] offset:14336
    s_waitcnt vmcnt(0) lgkmcnt(0)
    s_barrier
    ds_read_b128 v[96:99], v184 offset:0
    ds_read_b128 v[116:119], v185 offset:0
    ds_read_b128 v[136:139], v186 offset:0
    ds_read_b128 v[100:103], v184 offset:1024
    ds_read_b128 v[120:123], v185 offset:1024
    ds_read_b128 v[140:143], v186 offset:1024
    ds_read_b128 v[104:107], v184 offset:2048
    ds_read_b128 v[124:127], v185 offset:2048
    ds_read_b128 v[144:147], v186 offset:2048
    ds_read_b128 v[108:111], v184 offset:3072
    ds_read_b128 v[128:131], v185 offset:3072
    ds_read_b128 v[148:151], v186 offset:3072
    ds_read_b128 v[112:115], v184 offset:4096
    ds_read_b128 v[132:135], v185 offset:4096
    ds_read_b128 v[152:155], v186 offset:4096
    s_waitcnt lgkmcnt(12)
    v_pk_add_f32 v[96:97], v[96:97], v[116:117]
    v_pk_add_f32 v[98:99], v[98:99], v[118:119]
    v_pk_add_f32 v[16:17], v[16:17], v[136:137]
    v_pk_add_f32 v[18:19], v[18:19], v[138:139]
    v_pk_add_f32 v[16:17], v[16:17], v[96:97]
    v_pk_add_f32 v[18:19], v[18:19], v[98:99]
    v_mul_f32 v16, v192, v16
    v_mul_f32 v17, v192, v17
    v_mul_f32 v18, v192, v18
    v_mul_f32 v19, v192, v19
    v_cvt_pk_bf16_f32 v16, v16, v17
    v_cvt_pk_bf16_f32 v17, v18, v19
    buffer_store_dwordx2 v[16:17], v189, s[28:31], 0 offen
    s_waitcnt lgkmcnt(9)
    v_pk_add_f32 v[100:101], v[100:101], v[120:121]
    v_pk_add_f32 v[102:103], v[102:103], v[122:123]
    v_pk_add_f32 v[20:21], v[20:21], v[140:141]
    v_pk_add_f32 v[22:23], v[22:23], v[142:143]
    v_pk_add_f32 v[20:21], v[20:21], v[100:101]
    v_pk_add_f32 v[22:23], v[22:23], v[102:103]
    v_mul_f32 v20, v193, v20
    v_mul_f32 v21, v193, v21
    v_mul_f32 v22, v193, v22
    v_mul_f32 v23, v193, v23
    v_cvt_pk_bf16_f32 v20, v20, v21
    v_cvt_pk_bf16_f32 v21, v22, v23
    buffer_store_dwordx2 v[20:21], v189, s[28:31], s40 offen
    s_waitcnt lgkmcnt(6)
    v_pk_add_f32 v[104:105], v[104:105], v[124:125]
    v_pk_add_f32 v[106:107], v[106:107], v[126:127]
    v_pk_add_f32 v[24:25], v[24:25], v[144:145]
    v_pk_add_f32 v[26:27], v[26:27], v[146:147]
    v_pk_add_f32 v[24:25], v[24:25], v[104:105]
    v_pk_add_f32 v[26:27], v[26:27], v[106:107]
    v_mul_f32 v24, v194, v24
    v_mul_f32 v25, v194, v25
    v_mul_f32 v26, v194, v26
    v_mul_f32 v27, v194, v27
    v_cvt_pk_bf16_f32 v24, v24, v25
    v_cvt_pk_bf16_f32 v25, v26, v27
    buffer_store_dwordx2 v[24:25], v189, s[28:31], s41 offen
    s_waitcnt lgkmcnt(3)
    v_pk_add_f32 v[108:109], v[108:109], v[128:129]
    v_pk_add_f32 v[110:111], v[110:111], v[130:131]
    v_pk_add_f32 v[28:29], v[28:29], v[148:149]
    v_pk_add_f32 v[30:31], v[30:31], v[150:151]
    v_pk_add_f32 v[28:29], v[28:29], v[108:109]
    v_pk_add_f32 v[30:31], v[30:31], v[110:111]
    v_mul_f32 v28, v195, v28
    v_mul_f32 v29, v195, v29
    v_mul_f32 v30, v195, v30
    v_mul_f32 v31, v195, v31
    v_cvt_pk_bf16_f32 v28, v28, v29
    v_cvt_pk_bf16_f32 v29, v30, v31
    buffer_store_dwordx2 v[28:29], v189, s[28:31], s42 offen
    s_waitcnt lgkmcnt(0)
    v_pk_add_f32 v[112:113], v[112:113], v[132:133]
    v_pk_add_f32 v[114:115], v[114:115], v[134:135]
    v_pk_add_f32 v[32:33], v[32:33], v[152:153]
    v_pk_add_f32 v[34:35], v[34:35], v[154:155]
    v_pk_add_f32 v[32:33], v[32:33], v[112:113]
    v_pk_add_f32 v[34:35], v[34:35], v[114:115]
    v_mul_f32 v32, v196, v32
    v_mul_f32 v33, v196, v33
    v_mul_f32 v34, v196, v34
    v_mul_f32 v35, v196, v35
    v_cvt_pk_bf16_f32 v32, v32, v33
    v_cvt_pk_bf16_f32 v33, v34, v35
    buffer_store_dwordx2 v[32:33], v189, s[28:31], s43 offen
    s_endpgm
L_spare:
    s_cmp_ge_u32 s2, 8
    s_cbranch_scc1 L_nopf2
    v_add_u32 v2, 32768, v2
    v_min_u32 v2, L_end-L_pc-4, v2
    global_load_dword v11, v2, s[68:69]
L_nopf2:
    s_waitcnt lgkmcnt(0)
    s_mov_b64 s[24:25], s[60:61]
    s_mov_b32 s26, 16777216
    s_mov_b32 s27, 0x20000
    s_mov_b64 s[32:33], s[58:59]
    s_mov_b32 s34, 256
    s_mov_b32 s35, 0x20000
    s_or_b32 s70, s2, s62
    s_cmp_eq_u32 s70, 0
    s_cbranch_scc0 L_noclr
    v_lshlrev_b32 v5, 8, v0
    v_mov_b32 v6, 0
    v_lshlrev_b32 v7, 7, v0
    v_mov_b32 v8, 1
    buffer_store_dword v6, v7, s[24:27], 0 offen sc1
    v_add_u32 v7, 8192, v7
    buffer_store_dword v6, v7, s[24:27], 0 offen sc1
    v_add_u32 v7, 8192, v7
    buffer_store_dword v6, v7, s[24:27], 0 offen sc1
    v_add_u32 v7, 8192, v7
    buffer_store_dword v6, v7, s[24:27], 0 offen sc1
    v_add_u32 v7, 8192, v7
    buffer_store_dword v6, v7, s[24:27], 0 offen sc1
    v_add_u32 v7, 8192, v7
    s_waitcnt vmcnt(0)
    buffer_store_dword v8, v5, s[32:35], 0 offen sc1
L_noclr:
    s_mov_b64 s[20:21], s[44:45]
    s_mov_b32 s22, 401408
    s_mov_b32 s23, 0x20000
    s_mov_b64 s[16:17], s[52:53]
    s_mov_b32 s18, 1605632
    s_mov_b32 s19, 0x20000
    v_mov_b32 v249, 0
    s_mov_b32 s92, 0
SP19:
    buffer_load_dword v248, v249, s[32:35], 0 offen offset:4 sc1
    s_waitcnt vmcnt(0)
    v_cmp_ne_u32 vcc, 1, v248
    s_nop 1
    s_cbranch_vccz SD20
    s_add_u32 s92, s92, 1
    s_cmp_lt_u32 s92, 0x40000
    s_sleep 8
    s_cbranch_scc1 SP19
SD20:
    s_mul_i32 s66, s62, 10
    s_add_u32 s66, s66, s65
    s_lshl_b32 s66, s66, 6
    v_add_u32 v20, s66, v0
    v_add_u32 v21, 0, v20
    v_mul_u32_u24 v22, 9363, v21
    v_lshrrev_b32 v22, 22, v22
    v_add_u32 v22, 0, v22
    v_mul_u32_u24 v22, 448, v22
    v_add_u32 v22, v22, v21
    v_lshlrev_b32 v22, 7, v22
    buffer_load_dword v30, v22, s[16:19], 0 offen
    v_add_u32 v21, 2560, v20
    v_mul_u32_u24 v22, 9363, v21
    v_lshrrev_b32 v22, 22, v22
    v_add_u32 v22, 0, v22
    v_mul_u32_u24 v22, 448, v22
    v_add_u32 v22, v22, v21
    v_lshlrev_b32 v22, 7, v22
    buffer_load_dword v31, v22, s[16:19], 0 offen
    v_add_u32 v21, 5120, v20
    v_mul_u32_u24 v22, 9363, v21
    v_lshrrev_b32 v22, 22, v22
    v_add_u32 v22, 0, v22
    v_mul_u32_u24 v22, 448, v22
    v_add_u32 v22, v22, v21
    v_lshlrev_b32 v22, 7, v22
    buffer_load_dword v32, v22, s[16:19], 0 offen
    v_add_u32 v21, 0, v20
    v_mul_u32_u24 v22, 9363, v21
    v_lshrrev_b32 v22, 22, v22
    v_add_u32 v22, 1, v22
    v_mul_u32_u24 v22, 448, v22
    v_add_u32 v22, v22, v21
    v_lshlrev_b32 v22, 7, v22
    buffer_load_dword v33, v22, s[16:19], 0 offen
    v_add_u32 v21, 2560, v20
    v_mul_u32_u24 v22, 9363, v21
    v_lshrrev_b32 v22, 22, v22
    v_add_u32 v22, 1, v22
    v_mul_u32_u24 v22, 448, v22
    v_add_u32 v22, v22, v21
    v_lshlrev_b32 v22, 7, v22
    buffer_load_dword v34, v22, s[16:19], 0 offen
    v_add_u32 v21, 5120, v20
    v_mul_u32_u24 v22, 9363, v21
    v_lshrrev_b32 v22, 22, v22
    v_add_u32 v22, 1, v22
    v_mul_u32_u24 v22, 448, v22
    v_add_u32 v22, v22, v21
    v_lshlrev_b32 v22, 7, v22
    buffer_load_dword v35, v22, s[16:19], 0 offen
    v_add_u32 v21, 0, v20
    v_lshlrev_b32 v22, 7, v21
    buffer_load_dword v36, v22, s[20:23], 0 offen
    v_add_u32 v21, 2560, v20
    v_lshlrev_b32 v22, 7, v21
    buffer_load_dword v37, v22, s[20:23], 0 offen
L_exit:
    s_endpgm
L_attn:
    s_lshr_b32 s72, s63, 2
    s_lshl_b32 s72, s72, 3
    s_add_u32 s72, s72, s64
    s_sub_u32 s72, s72, 1
    s_and_b32 s73, s63, 3
    v_lshrrev_b32 v230, 3, v0
    v_and_b32 v231, 7, v0
    s_and_b32 s66, s62, 1
    s_lshl_b32 s67, s66, 2
    v_lshrrev_b32 v232, 1, v230
    v_or_b32 v232, s67, v232
    v_xor_b32 v232, v232, v231
    v_lshlrev_b32 v232, 4, v232
    s_lshl_b32 s70, s72, 7
    s_lshl_b32 s71, s62, 3
    s_add_u32 s70, s70, s71
    v_add_u32 v1, s70, v230
    v_mul_u32_u24 v1, 896, v1
    v_add_u32 v1, v1, v232
    v_add_u32 v2, 28672, v1
    v_add_u32 v3, 57344, v1
    v_add_u32 v4, 86016, v1
    v_add_u32 v5, 114688, v1
    s_cmp_lt_u32 s70, 16
    s_cselect_b32 s66, 2147483648, 0
    v_or_b32 v1, s66, v1
    s_cmp_ge_u32 s62, 2
    s_cselect_b32 s66, 2147483648, 0
    v_or_b32 v5, s66, v5
    v_lshrrev_b32 v230, 4, v0
    v_and_b32 v231, 15, v0
    s_and_b32 s66, s62, 2
    s_lshl_b32 s66, s66, 1
    v_or_b32 v232, s66, v230
    v_lshlrev_b32 v232, 1, v232
    v_xor_b32 v232, v232, v231
    s_lshl_b32 s66, s62, 2
    v_add_u32 v6, s66, v230
    v_mul_u32_u24 v6, 2688, v6
    v_lshl_add_u32 v6, v232, 4, v6
    s_mul_i32 s66, s73, 224
    v_add_u32 v6, s66, v6
    v_mov_b32 v233, 2147483648
    v_cmp_lt_u32 vcc, 13, v232
    s_nop 1
    v_cndmask_b32 v6, v6, v233, vcc
    s_lshl_b32 s66, s73, 1
    s_add_u32 s66, s66, s72
    s_mul_i32 s67, s66, 9363
    s_lshr_b32 s67, s67, 16
    s_mul_i32 s67, s67, 7
    s_sub_u32 s66, s66, s67
    s_sub_u32 s92, 6, s66
    s_lshl_b32 s87, s66, 7
    s_lshl_b32 s3, s66, 9
    s_mul_i32 s67, s66, 172032
    v_add_u32 v6, s67, v6
    s_mov_b32 s99, -1118208
    s_lshl_b32 s74, s62, 10
    s_add_u32 s74, s74, 98304
    s_mul_i32 s75, s62, 6144
    s_mov_b32 s76, 4096
    s_mov_b32 s77, 46080
    s_mov_b32 s78, 2944
    s_mov_b32 s79, 44928
    s_mov_b32 s80, 5888
    s_mov_b32 s81, 47872
    s_lshl_b32 s66, s62, 6
    v_add_u32 v234, s66, v0
    v_lshlrev_b32 v235, 2, v234
    s_waitcnt lgkmcnt(0)
    s_mov_b64 s[36:37], s[54:55]
    s_mov_b32 s38, 896
    s_mov_b32 s39, 0x20000
    s_sub_u32 s4, s40, 14336
    s_subb_u32 s5, s41, 0
    s_mov_b32 s6, 1849344
    s_mov_b32 s7, 0x20000
    s_sub_u32 s8, s42, 4096
    s_subb_u32 s9, s43, 0
    s_mov_b32 s10, 1208320
    s_mov_b32 s11, 0x20000
    s_lshl_b32 s46, s72, 2
    s_add_u32 s46, s46, s73
    s_lshl_b32 s46, s46, 2
    s_add_u32 s46, s46, s62
    v_min_u32 v240, 47, v0
    v_mul_u32_u24 v241, 21846, v240
    v_lshrrev_b32 v241, 16, v241
    v_mul_u32_u24 v242, 3, v241
    v_sub_u32 v242, v240, v242
    s_lshl_b32 s66, s46, 4
    v_add_u32 v243, s66, v241
    v_mul_u32_u24 v243, 896, v243
    v_lshl_add_u32 v243, v242, 8, v243
    v_add_u32 v243, 128, v243
    s_and_b32 s66, s46, 63
    v_min_u32 v241, 13, v241
    v_lshlrev_b32 v242, 7, v242
    v_add_u32 v242, s66, v242
    v_add_u32 v242, 64, v242
    v_mul_u32_u24 v242, 3584, v242
    v_lshl_add_u32 v242, v241, 8, v242
    s_cmp_ge_u32 s46, 192
    s_cselect_b32 s12, s50, s48
    s_cselect_b32 s13, s51, s49
    s_cmp_lt_u32 s46, 128
    s_cselect_b32 s12, s40, s12
    s_cselect_b32 s13, s41, s13
    s_cselect_b64 vcc, -1, 0
    s_mov_b32 s14, 1605632
    s_cselect_b32 s14, 1835008, s14
    s_mov_b32 s15, 0x20000
    v_cndmask_b32 v242, v242, v243, vcc
    buffer_load_dword a140, v242, s[12:15], 0 offen
    buffer_load_dword v236, v235, s[36:39], 0 offen
    s_mov_b32 s82, s87
    s_add_u32 s87, s87, 128
    s_cmp_eq_u32 s92, 0
    s_cselect_b32 s87, 0, s87
    s_add_u32 m0, s74, 0
    s_nop 0
    buffer_load_dwordx4 v1, s[4:7], s82 offen offset:0 lds
    s_add_u32 m0, s74, 4096
    s_nop 0
    buffer_load_dwordx4 v2, s[4:7], s82 offen offset:0 lds
    s_add_u32 m0, s74, 8192
    s_nop 0
    buffer_load_dwordx4 v3, s[4:7], s82 offen offset:0 lds
    s_add_u32 m0, s74, 12288
    s_nop 0
    buffer_load_dwordx4 v4, s[4:7], s82 offen offset:0 lds
    s_add_u32 m0, s74, 16384
    s_nop 0
    buffer_load_dwordx4 v5, s[4:7], s82 offen offset:0 lds
    s_mov_b64 s[24:25], s[60:61]
    s_mov_b32 s26, 16777216
    s_mov_b32 s27, 0x20000
    s_mov_b64 s[32:33], s[58:59]
    s_mov_b32 s34, 256
    s_mov_b32 s35, 0x20000
    s_mov_b64 s[20:21], s[44:45]
    s_mov_b32 s22, 401408
    s_mov_b32 s23, 0x20000
    s_mov_b64 s[16:17], s[52:53]
    s_mov_b32 s18, 1605632
    s_mov_b32 s19, 0x20000
    s_sub_u32 s66, s64, 1
    s_lshl_b32 s66, s66, 2
    s_add_u32 s66, s66, s62
    s_lshl_b32 s66, s66, 6
    v_add_u32 v227, s66, v0
    v_lshlrev_b32 v226, 7, v227
    s_mov_b32 s36, 262144
    v_lshrrev_b32 v230, 4, v0
    v_and_b32 v231, 15, v0
    v_lshrrev_b32 v232, 1, v231
    v_xor_b32 v232, v232, v230
    v_lshlrev_b32 v232, 4, v232
    v_lshl_add_u32 v232, v231, 7, v232
    v_add_u32 v7, 98304, v232
    v_xor_b32 v8, 64, v7
    v_bfe_u32 v232, v0, 2, 2
    v_and_b32 v233, 3, v0
    v_and_b32 v237, 1, v230
    v_lshl_add_u32 v238, v237, 2, v232
    v_lshlrev_b32 v238, 2, v238
    v_mul_u32_u24 v237, 12288, v237
    v_lshrrev_b32 v239, 1, v230
    v_lshl_add_u32 v237, v239, 10, v237
    v_lshl_add_u32 v237, v232, 8, v237
    s_mul_i32 s66, s62, 7
    v_add_u32 v239, s66, v233
    v_xor_b32 v240, v239, v238
    v_lshl_add_u32 v9, v240, 3, v237
    v_add_u32 v239, 4, v239
    v_and_b32 v240, 3, v239
    v_or_b32 v240, 28, v240
    v_cmp_eq_u32 vcc, 3, v233
    s_nop 1
    v_cndmask_b32 v239, v239, v240, vcc
    v_xor_b32 v240, v239, v238
    v_lshl_add_u32 v11, v240, 3, v237
    v_cndmask_b32 v15, 0, 1, vcc
    v_add_u32 v10, 49152, v9
    v_add_u32 v12, 49152, v11
    v_lshl_add_u32 v240, v230, 3, v232
    v_lshlrev_b32 v240, 3, v240
    v_add_u32 v240, 159744, v240
    v_cndmask_b32 v13, v11, v240, vcc
    v_cndmask_b32 v14, v12, v240, vcc
    s_waitcnt vmcnt(5)
    v_and_b32 v244, 0xffff, v236
    v_mov_b32 v245, 0
    v_lshrrev_b32 v246, 16, v236
    v_mov_b32 v247, 0
    v_lshlrev_b32 v234, 4, v234
    v_add_u32 v234, 159744, v234
    ds_write_b128 v234, v[244:247]
    s_add_u32 m0, s75, 0
    s_nop 0
    buffer_load_dwordx4 v6, s[8:11], s76 offen offset:0 lds
    buffer_load_dwordx4 v6, s[8:11], s77 offen offset:1024 lds
    buffer_load_dwordx4 v6, s[8:11], s78 offen offset:2048 lds
    buffer_load_dwordx4 v6, s[8:11], s79 offen offset:3072 lds
    s_add_u32 m0, s75, 4096
    s_nop 0
    buffer_load_dwordx4 v6, s[8:11], s80 offen offset:0 lds
    buffer_load_dwordx4 v6, s[8:11], s81 offen offset:1024 lds
    v_add_u32 v6, 86016, v6
    s_add_u32 m0, s75, 24576
    s_nop 0
    buffer_load_dwordx4 v6, s[8:11], s76 offen offset:0 lds
    buffer_load_dwordx4 v6, s[8:11], s77 offen offset:1024 lds
    buffer_load_dwordx4 v6, s[8:11], s78 offen offset:2048 lds
    buffer_load_dwordx4 v6, s[8:11], s79 offen offset:3072 lds
    s_add_u32 m0, s75, 28672
    s_nop 0
    buffer_load_dwordx4 v6, s[8:11], s80 offen offset:0 lds
    s_cmp_eq_u32 s92, 0
    s_cselect_b32 s93, s99, 86016
    buffer_load_dwordx4 v6, s[8:11], s81 offen offset:1024 lds
    v_add_u32 v6, s93, v6
    s_waitcnt vmcnt(6) lgkmcnt(0)
    s_barrier
    s_add_u32 s83, s3, 0
    v_mad_i32_i24 v224, v15, s83, v13
    s_add_u32 s84, s3, 4294961184
    v_mad_i32_i24 v225, v15, s84, v13
    ds_read_b64_tr_b16 a[72:73], v9 offset:0
    ds_read_b64_tr_b16 a[74:75], v9 offset:6144
    ds_read_b128 a[0:3], v7 offset:0
    ds_read_b128 a[4:7], v7 offset:2048
    ds_read_b128 a[8:11], v7 offset:4096
    ds_read_b128 a[12:15], v7 offset:6144
    ds_read_b128 a[16:19], v7 offset:8192
    ds_read_b128 a[20:23], v7 offset:10240
    ds_read_b128 a[24:27], v7 offset:12288
    ds_read_b128 a[28:31], v7 offset:14336
    ds_read_b128 a[32:35], v7 offset:16384
    ds_read_b64_tr_b16 a[76:77], v224 offset:0
    ds_read_b64_tr_b16 a[78:79], v225 offset:6144
    ds_read_b64_tr_b16 a[80:81], v9 offset:2048
    ds_read_b64_tr_b16 a[82:83], v9 offset:8192
    ds_read_b64_tr_b16 a[84:85], v11 offset:2048
    ds_read_b64_tr_b16 a[86:87], v11 offset:8192
    ds_read_b64_tr_b16 a[88:89], v9 offset:4096
    ds_read_b64_tr_b16 a[90:91], v9 offset:10240
    ds_read_b64_tr_b16 a[92:93], v11 offset:4096
    ds_read_b64_tr_b16 a[94:95], v11 offset:10240
    s_waitcnt lgkmcnt(0)
    v_mfma_f32_16x16x32_bf16 v[16:19], a[72:75], a[4:7], 0
    v_mfma_f32_16x16x32_bf16 v[24:27], a[72:75], a[8:11], 0
    s_mov_b32 s82, s87
    s_add_u32 s87, s87, 128
    s_add_u32 m0, s74, 20480
    v_mfma_f32_16x16x32_bf16 v[32:35], a[72:75], a[12:15], 0
    s_cmp_eq_u32 s92, 1
    s_cselect_b32 s87, 0, s87
    buffer_load_dwordx4 v1, s[4:7], s82 offen offset:0 lds
    v_mfma_f32_16x16x32_bf16 v[40:43], a[72:75], a[16:19], 0
    v_mfma_f32_16x16x32_bf16 v[48:51], a[72:75], a[20:23], 0
    v_mfma_f32_16x16x32_bf16 v[56:59], a[72:75], a[24:27], 0
    s_add_u32 m0, s74, 24576
    v_mfma_f32_16x16x32_bf16 v[64:67], a[72:75], a[28:31], 0
    buffer_load_dwordx4 v2, s[4:7], s82 offen offset:0 lds
    v_mfma_f32_16x16x32_bf16 v[72:75], a[72:75], a[32:35], 0
    v_mfma_f32_16x16x32_bf16 v[20:23], a[76:79], a[4:7], 0
    v_mfma_f32_16x16x32_bf16 v[28:31], a[76:79], a[8:11], 0
    s_add_u32 m0, s74, 28672
    v_mfma_f32_16x16x32_bf16 v[36:39], a[76:79], a[12:15], 0
    buffer_load_dwordx4 v3, s[4:7], s82 offen offset:0 lds
    v_mfma_f32_16x16x32_bf16 v[44:47], a[76:79], a[16:19], 0
    v_mfma_f32_16x16x32_bf16 v[52:55], a[76:79], a[20:23], 0
    v_mfma_f32_16x16x32_bf16 v[60:63], a[76:79], a[24:27], 0
    s_add_u32 m0, s74, 32768
    v_mfma_f32_16x16x32_bf16 v[68:71], a[76:79], a[28:31], 0
    v_mfma_f32_16x16x32_bf16 v[76:79], a[76:79], a[32:35], 0
    buffer_load_dwordx4 v4, s[4:7], s82 offen offset:0 lds
    v_mfma_f32_16x16x32_bf16 v[80:83], a[80:83], a[0:3], 0
    v_mfma_f32_16x16x32_bf16 v[88:91], a[80:83], a[4:7], 0
    v_mfma_f32_16x16x32_bf16 v[96:99], a[80:83], a[8:11], 0
    s_add_u32 m0, s74, 36864
    v_mfma_f32_16x16x32_bf16 v[104:107], a[80:83], a[12:15], 0
    buffer_load_dwordx4 v5, s[4:7], s82 offen offset:0 lds
    v_mfma_f32_16x16x32_bf16 v[112:115], a[80:83], a[16:19], 0
    v_mfma_f32_16x16x32_bf16 v[120:123], a[80:83], a[20:23], 0
    v_mfma_f32_16x16x32_bf16 v[128:131], a[80:83], a[24:27], 0
    s_add_u32 m0, s75, 49152
    v_mfma_f32_16x16x32_bf16 v[136:139], a[80:83], a[28:31], 0
    buffer_load_dwordx4 v6, s[8:11], s76 offen offset:0 lds
    v_mfma_f32_16x16x32_bf16 v[144:147], a[80:83], a[32:35], 0
    v_mfma_f32_16x16x32_bf16 v[84:87], a[84:87], a[0:3], 0
    s_waitcnt vmcnt(6)
    s_barrier
    v_mfma_f32_16x16x32_bf16 v[92:95], a[84:87], a[4:7], 0
    s_add_u32 s83, s3, 4294942976
    v_mad_i32_i24 v224, v15, s83, v13
    v_mfma_f32_16x16x32_bf16 v[100:103], a[84:87], a[8:11], 0
    s_add_u32 s84, s3, 4294936864
    v_mfma_f32_16x16x32_bf16 v[108:111], a[84:87], a[12:15], 0
    buffer_load_dwordx4 v6, s[8:11], s77 offen offset:1024 lds
    v_mad_i32_i24 v225, v15, s84, v13
    v_mfma_f32_16x16x32_bf16 v[116:119], a[84:87], a[16:19], 0
    s_add_u32 s3, s3, 512
    s_cmp_eq_u32 s92, 0
    s_cselect_b32 s3, 0, s3
    v_mfma_f32_16x16x32_bf16 v[124:127], a[84:87], a[20:23], 0
    ds_read_b64_tr_b16 a[96:97], v9 offset:24576
    v_mfma_f32_16x16x32_bf16 v[132:135], a[84:87], a[24:27], 0
    ds_read_b64_tr_b16 a[98:99], v9 offset:30720
    v_mfma_f32_16x16x32_bf16 v[140:143], a[84:87], a[28:31], 0
    ds_read_b128 a[36:39], v8 offset:0
    buffer_load_dwordx4 v6, s[8:11], s78 offen offset:2048 lds
    v_mfma_f32_16x16x32_bf16 v[148:151], a[84:87], a[32:35], 0
    ds_read_b128 a[40:43], v8 offset:2048
    ds_read_b128 a[44:47], v8 offset:4096
    v_mfma_f32_16x16x32_bf16 v[152:155], a[0:3], a[88:91], 0
    ds_read_b128 a[48:51], v8 offset:6144
    v_mfma_f32_16x16x32_bf16 v[156:159], a[4:7], a[88:91], 0
    ds_read_b128 a[52:55], v8 offset:8192
    v_mfma_f32_16x16x32_bf16 v[160:163], a[8:11], a[88:91], 0
    ds_read_b128 a[56:59], v8 offset:10240
    buffer_load_dwordx4 v6, s[8:11], s79 offen offset:3072 lds
    ds_read_b128 a[60:63], v8 offset:12288
    v_mfma_f32_16x16x32_bf16 v[164:167], a[12:15], a[88:91], 0
    ds_read_b128 a[64:67], v8 offset:14336
    v_mfma_f32_16x16x32_bf16 v[168:171], a[16:19], a[88:91], 0
    ds_read_b128 a[68:71], v8 offset:16384
    v_mfma_f32_16x16x32_bf16 v[172:175], a[20:23], a[88:91], 0
    s_add_u32 m0, s75, 53248
    ds_read_b64_tr_b16 a[100:101], v224 offset:24576
    v_mfma_f32_16x16x32_bf16 v[176:179], a[24:27], a[88:91], 0
    ds_read_b64_tr_b16 a[102:103], v225 offset:30720
    v_mfma_f32_16x16x32_bf16 v[180:183], a[28:31], a[88:91], 0
    ds_read_b64_tr_b16 a[104:105], v9 offset:26624
    buffer_load_dwordx4 v6, s[8:11], s80 offen offset:0 lds
    v_mfma_f32_16x16x32_bf16 v[184:187], a[32:35], a[88:91], 0
    ds_read_b64_tr_b16 a[106:107], v9 offset:32768
    v_mfma_f32_16x16x32_bf16 v[188:191], a[0:3], a[92:95], 0
    ds_read_b64_tr_b16 a[108:109], v11 offset:26624
    v_mfma_f32_16x16x32_bf16 v[192:195], a[4:7], a[92:95], 0
    ds_read_b64_tr_b16 a[110:111], v11 offset:32768
    v_mfma_f32_16x16x32_bf16 v[196:199], a[8:11], a[92:95], 0
    ds_read_b64_tr_b16 a[112:113], v9 offset:28672
    buffer_load_dwordx4 v6, s[8:11], s81 offen offset:1024 lds
    v_mfma_f32_16x16x32_bf16 v[200:203], a[12:15], a[92:95], 0
    ds_read_b64_tr_b16 a[114:115], v9 offset:34816
    v_add_u32 v6, 86016, v6
    v_mfma_f32_16x16x32_bf16 v[204:207], a[16:19], a[92:95], 0
    ds_read_b64_tr_b16 a[116:117], v11 offset:28672
    v_mfma_f32_16x16x32_bf16 v[208:211], a[20:23], a[92:95], 0
    s_add_u32 m0, s75, 73728
    ds_read_b64_tr_b16 a[118:119], v11 offset:34816
    v_mfma_f32_16x16x32_bf16 v[212:215], a[24:27], a[92:95], 0
    buffer_load_dwordx4 v6, s[8:11], s76 offen offset:0 lds
    v_mfma_f32_16x16x32_bf16 v[216:219], a[28:31], a[92:95], 0
    v_mfma_f32_16x16x32_bf16 v[220:223], a[32:35], a[92:95], 0
    s_waitcnt lgkmcnt(0)
    v_mfma_f32_16x16x32_bf16 v[16:19], a[96:99], a[40:43], v[16:19]
    v_mfma_f32_16x16x32_bf16 v[24:27], a[96:99], a[44:47], v[24:27]
    v_mfma_f32_16x16x32_bf16 v[32:35], a[96:99], a[48:51], v[32:35]
    buffer_load_dwordx4 v6, s[8:11], s77 offen offset:1024 lds
    v_mfma_f32_16x16x32_bf16 v[40:43], a[96:99], a[52:55], v[40:43]
    v_mfma_f32_16x16x32_bf16 v[48:51], a[96:99], a[56:59], v[48:51]
    v_mfma_f32_16x16x32_bf16 v[56:59], a[96:99], a[60:63], v[56:59]
    v_mfma_f32_16x16x32_bf16 v[64:67], a[96:99], a[64:67], v[64:67]
    buffer_load_dwordx4 v6, s[8:11], s78 offen offset:2048 lds
    v_mfma_f32_16x16x32_bf16 v[72:75], a[96:99], a[68:71], v[72:75]
    v_mfma_f32_16x16x32_bf16 v[20:23], a[100:103], a[40:43], v[20:23]
    v_mfma_f32_16x16x32_bf16 v[28:31], a[100:103], a[44:47], v[28:31]
    v_mfma_f32_16x16x32_bf16 v[36:39], a[100:103], a[48:51], v[36:39]
    buffer_load_dwordx4 v6, s[8:11], s79 offen offset:3072 lds
    v_mfma_f32_16x16x32_bf16 v[44:47], a[100:103], a[52:55], v[44:47]
    v_mfma_f32_16x16x32_bf16 v[52:55], a[100:103], a[56:59], v[52:55]
    v_mfma_f32_16x16x32_bf16 v[60:63], a[100:103], a[60:63], v[60:63]
    s_add_u32 m0, s75, 77824
    v_mfma_f32_16x16x32_bf16 v[68:71], a[100:103], a[64:67], v[68:71]
    v_mfma_f32_16x16x32_bf16 v[76:79], a[100:103], a[68:71], v[76:79]
    buffer_load_dwordx4 v6, s[8:11], s80 offen offset:0 lds
    v_mfma_f32_16x16x32_bf16 v[80:83], a[104:107], a[36:39], v[80:83]
    v_mfma_f32_16x16x32_bf16 v[88:91], a[104:107], a[40:43], v[88:91]
    v_mfma_f32_16x16x32_bf16 v[96:99], a[104:107], a[44:47], v[96:99]
    s_cmp_eq_u32 s92, 1
    s_cselect_b32 s93, s99, 86016
    v_mfma_f32_16x16x32_bf16 v[104:107], a[104:107], a[48:51], v[104:107]
    buffer_load_dwordx4 v6, s[8:11], s81 offen offset:1024 lds
    v_mfma_f32_16x16x32_bf16 v[112:115], a[104:107], a[52:55], v[112:115]
    v_add_u32 v6, s93, v6
    v_mfma_f32_16x16x32_bf16 v[120:123], a[104:107], a[56:59], v[120:123]
    v_mfma_f32_16x16x32_bf16 v[128:131], a[104:107], a[60:63], v[128:131]
    s_mov_b32 s82, s87
    s_add_u32 s87, s87, 128
    s_add_u32 m0, s74, 40960
    v_mfma_f32_16x16x32_bf16 v[136:139], a[104:107], a[64:67], v[136:139]
    s_cmp_eq_u32 s92, 2
    s_cselect_b32 s87, 0, s87
    buffer_load_dwordx4 v1, s[4:7], s82 offen offset:0 lds
    v_mfma_f32_16x16x32_bf16 v[144:147], a[104:107], a[68:71], v[144:147]
    v_mfma_f32_16x16x32_bf16 v[84:87], a[108:111], a[36:39], v[84:87]
    s_waitcnt vmcnt(7)
    s_barrier
    v_mfma_f32_16x16x32_bf16 v[92:95], a[108:111], a[40:43], v[92:95]
    s_add_u32 s83, s3, 0
    s_add_u32 m0, s74, 45056
    v_mad_i32_i24 v224, v15, s83, v14
    v_mfma_f32_16x16x32_bf16 v[100:103], a[108:111], a[44:47], v[100:103]
    s_add_u32 s84, s3, 4294961184
    v_mfma_f32_16x16x32_bf16 v[108:111], a[108:111], a[48:51], v[108:111]
    buffer_load_dwordx4 v2, s[4:7], s82 offen offset:0 lds
    v_mad_i32_i24 v225, v15, s84, v14
    v_mfma_f32_16x16x32_bf16 v[116:119], a[108:111], a[52:55], v[116:119]
    ds_read_b64_tr_b16 a[72:73], v10 offset:0
    v_mfma_f32_16x16x32_bf16 v[124:127], a[108:111], a[56:59], v[124:127]
    ds_read_b64_tr_b16 a[74:75], v10 offset:6144
    v_mfma_f32_16x16x32_bf16 v[132:135], a[108:111], a[60:63], v[132:135]
    s_add_u32 m0, s74, 49152
    ds_read_b128 a[0:3], v7 offset:20480
    ds_read_b128 a[4:7], v7 offset:22528
    v_mfma_f32_16x16x32_bf16 v[140:143], a[108:111], a[64:67], v[140:143]
    buffer_load_dwordx4 v3, s[4:7], s82 offen offset:0 lds
    ds_read_b128 a[8:11], v7 offset:24576
    v_mfma_f32_16x16x32_bf16 v[148:151], a[108:111], a[68:71], v[148:151]
    ds_read_b128 a[12:15], v7 offset:26624
    v_mfma_f32_16x16x32_bf16 v[152:155], a[36:39], a[112:115], v[152:155]
    ds_read_b128 a[16:19], v7 offset:28672
    v_mfma_f32_16x16x32_bf16 v[156:159], a[40:43], a[112:115], v[156:159]
    s_add_u32 m0, s74, 53248
    ds_read_b128 a[20:23], v7 offset:30720
    v_mfma_f32_16x16x32_bf16 v[160:163], a[44:47], a[112:115], v[160:163]
    ds_read_b128 a[24:27], v7 offset:32768
    buffer_load_dwordx4 v4, s[4:7], s82 offen offset:0 lds
    v_mfma_f32_16x16x32_bf16 v[164:167], a[48:51], a[112:115], v[164:167]
    ds_read_b128 a[28:31], v7 offset:34816
    v_mfma_f32_16x16x32_bf16 v[168:171], a[52:55], a[112:115], v[168:171]
    ds_read_b128 a[32:35], v7 offset:36864
    v_mfma_f32_16x16x32_bf16 v[172:175], a[56:59], a[112:115], v[172:175]
    s_add_u32 m0, s74, 57344
    ds_read_b64_tr_b16 a[76:77], v224 offset:0
    v_mfma_f32_16x16x32_bf16 v[176:179], a[60:63], a[112:115], v[176:179]
    ds_read_b64_tr_b16 a[78:79], v225 offset:6144
    v_mfma_f32_16x16x32_bf16 v[180:183], a[64:67], a[112:115], v[180:183]
    ds_read_b64_tr_b16 a[80:81], v10 offset:2048
    buffer_load_dwordx4 v5, s[4:7], s82 offen offset:0 lds
    v_mfma_f32_16x16x32_bf16 v[184:187], a[68:71], a[112:115], v[184:187]
    ds_read_b64_tr_b16 a[82:83], v10 offset:8192
    v_mfma_f32_16x16x32_bf16 v[188:191], a[36:39], a[116:119], v[188:191]
    ds_read_b64_tr_b16 a[84:85], v12 offset:2048
    v_mfma_f32_16x16x32_bf16 v[192:195], a[40:43], a[116:119], v[192:195]
    s_add_u32 m0, s75, 0
    ds_read_b64_tr_b16 a[86:87], v12 offset:8192
    v_mfma_f32_16x16x32_bf16 v[196:199], a[44:47], a[116:119], v[196:199]
    ds_read_b64_tr_b16 a[88:89], v10 offset:4096
    buffer_load_dwordx4 v6, s[8:11], s76 offen offset:0 lds
    v_mfma_f32_16x16x32_bf16 v[200:203], a[48:51], a[116:119], v[200:203]
    ds_read_b64_tr_b16 a[90:91], v10 offset:10240
    v_mfma_f32_16x16x32_bf16 v[204:207], a[52:55], a[116:119], v[204:207]
    ds_read_b64_tr_b16 a[92:93], v12 offset:4096
    v_mfma_f32_16x16x32_bf16 v[208:211], a[56:59], a[116:119], v[208:211]
    ds_read_b64_tr_b16 a[94:95], v12 offset:10240
    v_mfma_f32_16x16x32_bf16 v[212:215], a[60:63], a[116:119], v[212:215]
    buffer_load_dwordx4 v6, s[8:11], s77 offen offset:1024 lds
    v_mfma_f32_16x16x32_bf16 v[216:219], a[64:67], a[116:119], v[216:219]
    v_mfma_f32_16x16x32_bf16 v[220:223], a[68:71], a[116:119], v[220:223]
    s_waitcnt lgkmcnt(0)
    v_mfma_f32_16x16x32_bf16 v[16:19], a[72:75], a[4:7], v[16:19]
    v_mfma_f32_16x16x32_bf16 v[24:27], a[72:75], a[8:11], v[24:27]
    v_mfma_f32_16x16x32_bf16 v[32:35], a[72:75], a[12:15], v[32:35]
    buffer_load_dwordx4 v6, s[8:11], s78 offen offset:2048 lds
    v_mfma_f32_16x16x32_bf16 v[40:43], a[72:75], a[16:19], v[40:43]
    v_mfma_f32_16x16x32_bf16 v[48:51], a[72:75], a[20:23], v[48:51]
    v_mfma_f32_16x16x32_bf16 v[56:59], a[72:75], a[24:27], v[56:59]
    v_mfma_f32_16x16x32_bf16 v[64:67], a[72:75], a[28:31], v[64:67]
    buffer_load_dwordx4 v6, s[8:11], s79 offen offset:3072 lds
    v_mfma_f32_16x16x32_bf16 v[72:75], a[72:75], a[32:35], v[72:75]
    v_mfma_f32_16x16x32_bf16 v[20:23], a[76:79], a[4:7], v[20:23]
    v_mfma_f32_16x16x32_bf16 v[28:31], a[76:79], a[8:11], v[28:31]
    s_add_u32 m0, s75, 4096
    v_mfma_f32_16x16x32_bf16 v[36:39], a[76:79], a[12:15], v[36:39]
    buffer_load_dwordx4 v6, s[8:11], s80 offen offset:0 lds
    v_mfma_f32_16x16x32_bf16 v[44:47], a[76:79], a[16:19], v[44:47]
    v_mfma_f32_16x16x32_bf16 v[52:55], a[76:79], a[20:23], v[52:55]
    v_mfma_f32_16x16x32_bf16 v[60:63], a[76:79], a[24:27], v[60:63]
    v_mfma_f32_16x16x32_bf16 v[68:71], a[76:79], a[28:31], v[68:71]
    v_mfma_f32_16x16x32_bf16 v[76:79], a[76:79], a[32:35], v[76:79]
    buffer_load_dwordx4 v6, s[8:11], s81 offen offset:1024 lds
    v_mfma_f32_16x16x32_bf16 v[80:83], a[80:83], a[0:3], v[80:83]
    v_add_u32 v6, 86016, v6
    v_mfma_f32_16x16x32_bf16 v[88:91], a[80:83], a[4:7], v[88:91]
    v_mfma_f32_16x16x32_bf16 v[96:99], a[80:83], a[8:11], v[96:99]
    s_add_u32 m0, s75, 24576
    v_mfma_f32_16x16x32_bf16 v[104:107], a[80:83], a[12:15], v[104:107]
    buffer_load_dwordx4 v6, s[8:11], s76 offen offset:0 lds
    v_mfma_f32_16x16x32_bf16 v[112:115], a[80:83], a[16:19], v[112:115]
    v_mfma_f32_16x16x32_bf16 v[120:123], a[80:83], a[20:23], v[120:123]
    v_mfma_f32_16x16x32_bf16 v[128:131], a[80:83], a[24:27], v[128:131]
    v_mfma_f32_16x16x32_bf16 v[136:139], a[80:83], a[28:31], v[136:139]
    buffer_load_dwordx4 v6, s[8:11], s77 offen offset:1024 lds
    v_mfma_f32_16x16x32_bf16 v[144:147], a[80:83], a[32:35], v[144:147]
    v_mfma_f32_16x16x32_bf16 v[84:87], a[84:87], a[0:3], v[84:87]
    s_waitcnt vmcnt(13)
    s_barrier
    v_mfma_f32_16x16x32_bf16 v[92:95], a[84:87], a[4:7], v[92:95]
    s_add_u32 s83, s3, 4294942976
    v_mad_i32_i24 v224, v15, s83, v14
    v_mfma_f32_16x16x32_bf16 v[100:103], a[84:87], a[8:11], v[100:103]
    s_add_u32 s84, s3, 4294936864
    v_mfma_f32_16x16x32_bf16 v[108:111], a[84:87], a[12:15], v[108:111]
    buffer_load_dwordx4 v6, s[8:11], s78 offen offset:2048 lds
    v_mad_i32_i24 v225, v15, s84, v14
    v_mfma_f32_16x16x32_bf16 v[116:119], a[84:87], a[16:19], v[116:119]
    s_add_u32 s3, s3, 512
    s_cmp_eq_u32 s92, 1
    s_cselect_b32 s3, 0, s3
    v_mfma_f32_16x16x32_bf16 v[124:127], a[84:87], a[20:23], v[124:127]
    ds_read_b64_tr_b16 a[96:97], v10 offset:24576
    v_mfma_f32_16x16x32_bf16 v[132:135], a[84:87], a[24:27], v[132:135]
    ds_read_b64_tr_b16 a[98:99], v10 offset:30720
    v_mfma_f32_16x16x32_bf16 v[140:143], a[84:87], a[28:31], v[140:143]
    ds_read_b128 a[36:39], v8 offset:20480
    buffer_load_dwordx4 v6, s[8:11], s79 offen offset:3072 lds
    v_mfma_f32_16x16x32_bf16 v[148:151], a[84:87], a[32:35], v[148:151]
    ds_read_b128 a[40:43], v8 offset:22528
    ds_read_b128 a[44:47], v8 offset:24576
    v_mfma_f32_16x16x32_bf16 v[152:155], a[0:3], a[88:91], v[152:155]
    ds_read_b128 a[48:51], v8 offset:26624
    v_mfma_f32_16x16x32_bf16 v[156:159], a[4:7], a[88:91], v[156:159]
    s_add_u32 m0, s75, 28672
    ds_read_b128 a[52:55], v8 offset:28672
    v_mfma_f32_16x16x32_bf16 v[160:163], a[8:11], a[88:91], v[160:163]
    ds_read_b128 a[56:59], v8 offset:30720
    buffer_load_dwordx4 v6, s[8:11], s80 offen offset:0 lds
    ds_read_b128 a[60:63], v8 offset:32768
    v_mfma_f32_16x16x32_bf16 v[164:167], a[12:15], a[88:91], v[164:167]
    ds_read_b128 a[64:67], v8 offset:34816
    v_mfma_f32_16x16x32_bf16 v[168:171], a[16:19], a[88:91], v[168:171]
    ds_read_b128 a[68:71], v8 offset:36864
    v_mfma_f32_16x16x32_bf16 v[172:175], a[20:23], a[88:91], v[172:175]
    s_cmp_eq_u32 s92, 2
    s_cselect_b32 s93, s99, 86016
    ds_read_b64_tr_b16 a[100:101], v224 offset:24576
    v_mfma_f32_16x16x32_bf16 v[176:179], a[24:27], a[88:91], v[176:179]
    ds_read_b64_tr_b16 a[102:103], v225 offset:30720
    v_mfma_f32_16x16x32_bf16 v[180:183], a[28:31], a[88:91], v[180:183]
    ds_read_b64_tr_b16 a[104:105], v10 offset:26624
    buffer_load_dwordx4 v6, s[8:11], s81 offen offset:1024 lds
    v_mfma_f32_16x16x32_bf16 v[184:187], a[32:35], a[88:91], v[184:187]
    ds_read_b64_tr_b16 a[106:107], v10 offset:32768
    v_add_u32 v6, s93, v6
    v_mfma_f32_16x16x32_bf16 v[188:191], a[0:3], a[92:95], v[188:191]
    ds_read_b64_tr_b16 a[108:109], v12 offset:26624
    v_mfma_f32_16x16x32_bf16 v[192:195], a[4:7], a[92:95], v[192:195]
    s_mov_b32 s82, s87
    s_add_u32 s87, s87, 128
    ds_read_b64_tr_b16 a[110:111], v12 offset:32768
    v_mfma_f32_16x16x32_bf16 v[196:199], a[8:11], a[92:95], v[196:199]
    s_cmp_eq_u32 s92, 3
    s_cselect_b32 s87, 0, s87
    ds_read_b64_tr_b16 a[112:113], v10 offset:28672
    v_mfma_f32_16x16x32_bf16 v[200:203], a[12:15], a[92:95], v[200:203]
    s_add_u32 m0, s74, 0
    ds_read_b64_tr_b16 a[114:115], v10 offset:34816
    buffer_load_dwordx4 v1, s[4:7], s82 offen offset:0 lds
    v_mfma_f32_16x16x32_bf16 v[204:207], a[16:19], a[92:95], v[204:207]
    ds_read_b64_tr_b16 a[116:117], v12 offset:28672
    v_mfma_f32_16x16x32_bf16 v[208:211], a[20:23], a[92:95], v[208:211]
    s_add_u32 m0, s74, 4096
    ds_read_b64_tr_b16 a[118:119], v12 offset:34816
    v_mfma_f32_16x16x32_bf16 v[212:215], a[24:27], a[92:95], v[212:215]
    buffer_load_dwordx4 v2, s[4:7], s82 offen offset:0 lds
    v_mfma_f32_16x16x32_bf16 v[216:219], a[28:31], a[92:95], v[216:219]
    v_mfma_f32_16x16x32_bf16 v[220:223], a[32:35], a[92:95], v[220:223]
    s_waitcnt lgkmcnt(0)
    v_mfma_f32_16x16x32_bf16 v[16:19], a[96:99], a[40:43], v[16:19]
    v_mfma_f32_16x16x32_bf16 v[24:27], a[96:99], a[44:47], v[24:27]
    s_add_u32 m0, s74, 8192
    v_mfma_f32_16x16x32_bf16 v[32:35], a[96:99], a[48:51], v[32:35]
    buffer_load_dwordx4 v3, s[4:7], s82 offen offset:0 lds
    v_mfma_f32_16x16x32_bf16 v[40:43], a[96:99], a[52:55], v[40:43]
    v_mfma_f32_16x16x32_bf16 v[48:51], a[96:99], a[56:59], v[48:51]
    v_mfma_f32_16x16x32_bf16 v[56:59], a[96:99], a[60:63], v[56:59]
    s_add_u32 m0, s74, 12288
    v_mfma_f32_16x16x32_bf16 v[64:67], a[96:99], a[64:67], v[64:67]
    buffer_load_dwordx4 v4, s[4:7], s82 offen offset:0 lds
    v_mfma_f32_16x16x32_bf16 v[72:75], a[96:99], a[68:71], v[72:75]
    v_mfma_f32_16x16x32_bf16 v[20:23], a[100:103], a[40:43], v[20:23]
    v_mfma_f32_16x16x32_bf16 v[28:31], a[100:103], a[44:47], v[28:31]
    s_add_u32 m0, s74, 16384
    v_mfma_f32_16x16x32_bf16 v[36:39], a[100:103], a[48:51], v[36:39]
    buffer_load_dwordx4 v5, s[4:7], s82 offen offset:0 lds
    v_mfma_f32_16x16x32_bf16 v[44:47], a[100:103], a[52:55], v[44:47]
    v_mfma_f32_16x16x32_bf16 v[52:55], a[100:103], a[56:59], v[52:55]
    v_mfma_f32_16x16x32_bf16 v[60:63], a[100:103], a[60:63], v[60:63]
    s_add_u32 m0, s75, 49152
    v_mfma_f32_16x16x32_bf16 v[68:71], a[100:103], a[64:67], v[68:71]
    v_mfma_f32_16x16x32_bf16 v[76:79], a[100:103], a[68:71], v[76:79]
    buffer_load_dwordx4 v6, s[8:11], s76 offen offset:0 lds
    v_mfma_f32_16x16x32_bf16 v[80:83], a[104:107], a[36:39], v[80:83]
    v_mfma_f32_16x16x32_bf16 v[88:91], a[104:107], a[40:43], v[88:91]
    v_mfma_f32_16x16x32_bf16 v[96:99], a[104:107], a[44:47], v[96:99]
    v_mfma_f32_16x16x32_bf16 v[104:107], a[104:107], a[48:51], v[104:107]
    buffer_load_dwordx4 v6, s[8:11], s77 offen offset:1024 lds
    v_mfma_f32_16x16x32_bf16 v[112:115], a[104:107], a[52:55], v[112:115]
    v_mfma_f32_16x16x32_bf16 v[120:123], a[104:107], a[56:59], v[120:123]
    v_mfma_f32_16x16x32_bf16 v[128:131], a[104:107], a[60:63], v[128:131]
    v_mfma_f32_16x16x32_bf16 v[136:139], a[104:107], a[64:67], v[136:139]
    buffer_load_dwordx4 v6, s[8:11], s78 offen offset:2048 lds
    v_mfma_f32_16x16x32_bf16 v[144:147], a[104:107], a[68:71], v[144:147]
    v_mfma_f32_16x16x32_bf16 v[84:87], a[108:111], a[36:39], v[84:87]
    s_waitcnt vmcnt(14)
    s_barrier
    v_mfma_f32_16x16x32_bf16 v[92:95], a[108:111], a[40:43], v[92:95]
    s_add_u32 s83, s3, 0
    v_mad_i32_i24 v224, v15, s83, v13
    v_mfma_f32_16x16x32_bf16 v[100:103], a[108:111], a[44:47], v[100:103]
    s_add_u32 s84, s3, 4294961184
    v_mfma_f32_16x16x32_bf16 v[108:111], a[108:111], a[48:51], v[108:111]
    buffer_load_dwordx4 v6, s[8:11], s79 offen offset:3072 lds
    v_mad_i32_i24 v225, v15, s84, v13
    v_mfma_f32_16x16x32_bf16 v[116:119], a[108:111], a[52:55], v[116:119]
    ds_read_b64_tr_b16 a[72:73], v9 offset:0
    v_mfma_f32_16x16x32_bf16 v[124:127], a[108:111], a[56:59], v[124:127]
    ds_read_b64_tr_b16 a[74:75], v9 offset:6144
    v_mfma_f32_16x16x32_bf16 v[132:135], a[108:111], a[60:63], v[132:135]
    s_add_u32 m0, s75, 53248
    ds_read_b128 a[0:3], v7 offset:40960
    ds_read_b128 a[4:7], v7 offset:43008
    v_mfma_f32_16x16x32_bf16 v[140:143], a[108:111], a[64:67], v[140:143]
    buffer_load_dwordx4 v6, s[8:11], s80 offen offset:0 lds
    ds_read_b128 a[8:11], v7 offset:45056
    v_mfma_f32_16x16x32_bf16 v[148:151], a[108:111], a[68:71], v[148:151]
    ds_read_b128 a[12:15], v7 offset:47104
    v_mfma_f32_16x16x32_bf16 v[152:155], a[36:39], a[112:115], v[152:155]
    ds_read_b128 a[16:19], v7 offset:49152
    v_mfma_f32_16x16x32_bf16 v[156:159], a[40:43], a[112:115], v[156:159]
    ds_read_b128 a[20:23], v7 offset:51200
    v_mfma_f32_16x16x32_bf16 v[160:163], a[44:47], a[112:115], v[160:163]
    ds_read_b128 a[24:27], v7 offset:53248
    buffer_load_dwordx4 v6, s[8:11], s81 offen offset:1024 lds
    v_mfma_f32_16x16x32_bf16 v[164:167], a[48:51], a[112:115], v[164:167]
    ds_read_b128 a[28:31], v7 offset:55296
    v_add_u32 v6, 86016, v6
    v_mfma_f32_16x16x32_bf16 v[168:171], a[52:55], a[112:115], v[168:171]
    ds_read_b128 a[32:35], v7 offset:57344
    v_mfma_f32_16x16x32_bf16 v[172:175], a[56:59], a[112:115], v[172:175]
    ds_read_b64_tr_b16 a[76:77], v224 offset:0
    v_mfma_f32_16x16x32_bf16 v[176:179], a[60:63], a[112:115], v[176:179]
    ds_read_b64_tr_b16 a[78:79], v225 offset:6144
    v_mfma_f32_16x16x32_bf16 v[180:183], a[64:67], a[112:115], v[180:183]
    ds_read_b64_tr_b16 a[80:81], v9 offset:2048
    v_mfma_f32_16x16x32_bf16 v[184:187], a[68:71], a[112:115], v[184:187]
    ds_read_b64_tr_b16 a[82:83], v9 offset:8192
    v_mfma_f32_16x16x32_bf16 v[188:191], a[36:39], a[116:119], v[188:191]
    ds_read_b64_tr_b16 a[84:85], v11 offset:2048
    v_mfma_f32_16x16x32_bf16 v[192:195], a[40:43], a[116:119], v[192:195]
    ds_read_b64_tr_b16 a[86:87], v11 offset:8192
    v_mfma_f32_16x16x32_bf16 v[196:199], a[44:47], a[116:119], v[196:199]
    ds_read_b64_tr_b16 a[88:89], v9 offset:4096
    v_mfma_f32_16x16x32_bf16 v[200:203], a[48:51], a[116:119], v[200:203]
    ds_read_b64_tr_b16 a[90:91], v9 offset:10240
    v_mfma_f32_16x16x32_bf16 v[204:207], a[52:55], a[116:119], v[204:207]
    ds_read_b64_tr_b16 a[92:93], v11 offset:4096
    v_mfma_f32_16x16x32_bf16 v[208:211], a[56:59], a[116:119], v[208:211]
    ds_read_b64_tr_b16 a[94:95], v11 offset:10240
    v_mfma_f32_16x16x32_bf16 v[212:215], a[60:63], a[116:119], v[212:215]
    v_mfma_f32_16x16x32_bf16 v[216:219], a[64:67], a[116:119], v[216:219]
    v_mfma_f32_16x16x32_bf16 v[220:223], a[68:71], a[116:119], v[220:223]
    s_waitcnt vmcnt(11) lgkmcnt(0)
    s_barrier
    v_mfma_f32_16x16x32_bf16 v[16:19], a[72:75], a[4:7], v[16:19]
    s_add_u32 s83, s3, 4294942976
    v_mfma_f32_16x16x32_bf16 v[24:27], a[72:75], a[8:11], v[24:27]
    s_add_u32 m0, s75, 73728
    v_mad_i32_i24 v224, v15, s83, v13
    v_mfma_f32_16x16x32_bf16 v[32:35], a[72:75], a[12:15], v[32:35]
    s_add_u32 s84, s3, 4294936864
    buffer_load_dwordx4 v6, s[8:11], s76 offen offset:0 lds
    v_mfma_f32_16x16x32_bf16 v[40:43], a[72:75], a[16:19], v[40:43]
    v_mfma_f32_16x16x32_bf16 v[48:51], a[72:75], a[20:23], v[48:51]
    v_mad_i32_i24 v225, v15, s84, v13
    v_mfma_f32_16x16x32_bf16 v[56:59], a[72:75], a[24:27], v[56:59]
    s_add_u32 s3, s3, 512
    v_mfma_f32_16x16x32_bf16 v[64:67], a[72:75], a[28:31], v[64:67]
    s_cmp_eq_u32 s92, 2
    s_cselect_b32 s3, 0, s3
    buffer_load_dwordx4 v6, s[8:11], s77 offen offset:1024 lds
    v_mfma_f32_16x16x32_bf16 v[72:75], a[72:75], a[32:35], v[72:75]
    v_mfma_f32_16x16x32_bf16 v[20:23], a[76:79], a[4:7], v[20:23]
    ds_read_b64_tr_b16 a[96:97], v9 offset:24576
    v_mfma_f32_16x16x32_bf16 v[28:31], a[76:79], a[8:11], v[28:31]
    ds_read_b64_tr_b16 a[98:99], v9 offset:30720
    v_mfma_f32_16x16x32_bf16 v[36:39], a[76:79], a[12:15], v[36:39]
    ds_read_b128 a[36:39], v8 offset:40960
    buffer_load_dwordx4 v6, s[8:11], s78 offen offset:2048 lds
    v_mfma_f32_16x16x32_bf16 v[44:47], a[76:79], a[16:19], v[44:47]
    v_mfma_f32_16x16x32_bf16 v[52:55], a[76:79], a[20:23], v[52:55]
    ds_read_b128 a[40:43], v8 offset:43008
    v_mfma_f32_16x16x32_bf16 v[60:63], a[76:79], a[24:27], v[60:63]
    ds_read_b128 a[44:47], v8 offset:45056
    v_mfma_f32_16x16x32_bf16 v[68:71], a[76:79], a[28:31], v[68:71]
    ds_read_b128 a[48:51], v8 offset:47104
    v_mfma_f32_16x16x32_bf16 v[76:79], a[76:79], a[32:35], v[76:79]
    buffer_load_dwordx4 v6, s[8:11], s79 offen offset:3072 lds
    v_mfma_f32_16x16x32_bf16 v[80:83], a[80:83], a[0:3], v[80:83]
    ds_read_b128 a[52:55], v8 offset:49152
    v_mfma_f32_16x16x32_bf16 v[88:91], a[80:83], a[4:7], v[88:91]
    ds_read_b128 a[56:59], v8 offset:51200
    v_mfma_f32_16x16x32_bf16 v[96:99], a[80:83], a[8:11], v[96:99]
    s_add_u32 m0, s75, 77824
    ds_read_b128 a[60:63], v8 offset:53248
    v_mfma_f32_16x16x32_bf16 v[104:107], a[80:83], a[12:15], v[104:107]
    buffer_load_dwordx4 v6, s[8:11], s80 offen offset:0 lds
    v_mfma_f32_16x16x32_bf16 v[112:115], a[80:83], a[16:19], v[112:115]
    ds_read_b128 a[64:67], v8 offset:55296
    v_mfma_f32_16x16x32_bf16 v[120:123], a[80:83], a[20:23], v[120:123]
    ds_read_b128 a[68:71], v8 offset:57344
    v_mfma_f32_16x16x32_bf16 v[128:131], a[80:83], a[24:27], v[128:131]
    s_cmp_eq_u32 s92, 3
    s_cselect_b32 s93, s99, 86016
    ds_read_b64_tr_b16 a[100:101], v224 offset:24576
    v_mfma_f32_16x16x32_bf16 v[136:139], a[80:83], a[28:31], v[136:139]
    buffer_load_dwordx4 v6, s[8:11], s81 offen offset:1024 lds
    v_mfma_f32_16x16x32_bf16 v[144:147], a[80:83], a[32:35], v[144:147]
    ds_read_b64_tr_b16 a[102:103], v225 offset:30720
    v_add_u32 v6, s93, v6
    v_mfma_f32_16x16x32_bf16 v[84:87], a[84:87], a[0:3], v[84:87]
    ds_read_b64_tr_b16 a[104:105], v9 offset:26624
    v_mfma_f32_16x16x32_bf16 v[92:95], a[84:87], a[4:7], v[92:95]
    s_mov_b32 s82, s87
    s_add_u32 s87, s87, 128
    ds_read_b64_tr_b16 a[106:107], v9 offset:32768
    v_mfma_f32_16x16x32_bf16 v[100:103], a[84:87], a[8:11], v[100:103]
    s_cmp_eq_u32 s92, 4
    s_cselect_b32 s87, 0, s87
    s_add_u32 m0, s74, 20480
    v_mfma_f32_16x16x32_bf16 v[108:111], a[84:87], a[12:15], v[108:111]
    ds_read_b64_tr_b16 a[108:109], v11 offset:26624
    buffer_load_dwordx4 v1, s[4:7], s82 offen offset:0 lds
    v_mfma_f32_16x16x32_bf16 v[116:119], a[84:87], a[16:19], v[116:119]
    ds_read_b64_tr_b16 a[110:111], v11 offset:32768
    v_mfma_f32_16x16x32_bf16 v[124:127], a[84:87], a[20:23], v[124:127]
    ds_read_b64_tr_b16 a[112:113], v9 offset:28672
    v_mfma_f32_16x16x32_bf16 v[132:135], a[84:87], a[24:27], v[132:135]
    s_add_u32 m0, s74, 24576
    v_mfma_f32_16x16x32_bf16 v[140:143], a[84:87], a[28:31], v[140:143]
    ds_read_b64_tr_b16 a[114:115], v9 offset:34816
    buffer_load_dwordx4 v2, s[4:7], s82 offen offset:0 lds
    v_mfma_f32_16x16x32_bf16 v[148:151], a[84:87], a[32:35], v[148:151]
    ds_read_b64_tr_b16 a[116:117], v11 offset:28672
    v_mfma_f32_16x16x32_bf16 v[152:155], a[0:3], a[88:91], v[152:155]
    ds_read_b64_tr_b16 a[118:119], v11 offset:34816
    v_mfma_f32_16x16x32_bf16 v[156:159], a[4:7], a[88:91], v[156:159]
    s_add_u32 m0, s74, 28672
    v_mfma_f32_16x16x32_bf16 v[160:163], a[8:11], a[88:91], v[160:163]
    buffer_load_dwordx4 v3, s[4:7], s82 offen offset:0 lds
    v_mfma_f32_16x16x32_bf16 v[164:167], a[12:15], a[88:91], v[164:167]
    v_mfma_f32_16x16x32_bf16 v[168:171], a[16:19], a[88:91], v[168:171]
    v_mfma_f32_16x16x32_bf16 v[172:175], a[20:23], a[88:91], v[172:175]
    s_add_u32 m0, s74, 32768
    v_mfma_f32_16x16x32_bf16 v[176:179], a[24:27], a[88:91], v[176:179]
    v_mfma_f32_16x16x32_bf16 v[180:183], a[28:31], a[88:91], v[180:183]
    buffer_load_dwordx4 v4, s[4:7], s82 offen offset:0 lds
    v_mfma_f32_16x16x32_bf16 v[184:187], a[32:35], a[88:91], v[184:187]
    v_mfma_f32_16x16x32_bf16 v[188:191], a[0:3], a[92:95], v[188:191]
    v_mfma_f32_16x16x32_bf16 v[192:195], a[4:7], a[92:95], v[192:195]
    s_add_u32 m0, s74, 36864
    v_mfma_f32_16x16x32_bf16 v[196:199], a[8:11], a[92:95], v[196:199]
    buffer_load_dwordx4 v5, s[4:7], s82 offen offset:0 lds
    v_mfma_f32_16x16x32_bf16 v[200:203], a[12:15], a[92:95], v[200:203]
    v_mfma_f32_16x16x32_bf16 v[204:207], a[16:19], a[92:95], v[204:207]
    v_mfma_f32_16x16x32_bf16 v[208:211], a[20:23], a[92:95], v[208:211]
    s_add_u32 m0, s75, 0
    v_mfma_f32_16x16x32_bf16 v[212:215], a[24:27], a[92:95], v[212:215]
    buffer_load_dwordx4 v6, s[8:11], s76 offen offset:0 lds
    v_mfma_f32_16x16x32_bf16 v[216:219], a[28:31], a[92:95], v[216:219]
    v_mfma_f32_16x16x32_bf16 v[220:223], a[32:35], a[92:95], v[220:223]
    s_waitcnt vmcnt(12) lgkmcnt(0)
    s_barrier
    v_mfma_f32_16x16x32_bf16 v[16:19], a[96:99], a[40:43], v[16:19]
    s_add_u32 s83, s3, 0
    v_mfma_f32_16x16x32_bf16 v[24:27], a[96:99], a[44:47], v[24:27]
    v_mad_i32_i24 v224, v15, s83, v14
    v_mfma_f32_16x16x32_bf16 v[32:35], a[96:99], a[48:51], v[32:35]
    s_add_u32 s84, s3, 4294961184
    buffer_load_dwordx4 v6, s[8:11], s77 offen offset:1024 lds
    v_mfma_f32_16x16x32_bf16 v[40:43], a[96:99], a[52:55], v[40:43]
    v_mfma_f32_16x16x32_bf16 v[48:51], a[96:99], a[56:59], v[48:51]
    v_mad_i32_i24 v225, v15, s84, v14
    v_mfma_f32_16x16x32_bf16 v[56:59], a[96:99], a[60:63], v[56:59]
    ds_read_b64_tr_b16 a[72:73], v10 offset:0
    v_mfma_f32_16x16x32_bf16 v[64:67], a[96:99], a[64:67], v[64:67]
    buffer_load_dwordx4 v6, s[8:11], s78 offen offset:2048 lds
    v_mfma_f32_16x16x32_bf16 v[72:75], a[96:99], a[68:71], v[72:75]
    ds_read_b64_tr_b16 a[74:75], v10 offset:6144
    v_mfma_f32_16x16x32_bf16 v[20:23], a[100:103], a[40:43], v[20:23]
    ds_read_b128 a[0:3], v7 offset:0
    v_mfma_f32_16x16x32_bf16 v[28:31], a[100:103], a[44:47], v[28:31]
    v_mfma_f32_16x16x32_bf16 v[36:39], a[100:103], a[48:51], v[36:39]
    ds_read_b128 a[4:7], v7 offset:2048
    buffer_load_dwordx4 v6, s[8:11], s79 offen offset:3072 lds
    v_mfma_f32_16x16x32_bf16 v[44:47], a[100:103], a[52:55], v[44:47]
    ds_read_b128 a[8:11], v7 offset:4096
    v_mfma_f32_16x16x32_bf16 v[52:55], a[100:103], a[56:59], v[52:55]
    ds_read_b128 a[12:15], v7 offset:6144
    v_mfma_f32_16x16x32_bf16 v[60:63], a[100:103], a[60:63], v[60:63]
    s_add_u32 m0, s75, 4096
    v_mfma_f32_16x16x32_bf16 v[68:71], a[100:103], a[64:67], v[68:71]
    ds_read_b128 a[16:19], v7 offset:8192
    v_mfma_f32_16x16x32_bf16 v[76:79], a[100:103], a[68:71], v[76:79]
    buffer_load_dwordx4 v6, s[8:11], s80 offen offset:0 lds
    ds_read_b128 a[20:23], v7 offset:10240
    v_mfma_f32_16x16x32_bf16 v[80:83], a[104:107], a[36:39], v[80:83]
    v_mfma_f32_16x16x32_bf16 v[88:91], a[104:107], a[40:43], v[88:91]
    ds_read_b128 a[24:27], v7 offset:12288
    v_mfma_f32_16x16x32_bf16 v[96:99], a[104:107], a[44:47], v[96:99]
    ds_read_b128 a[28:31], v7 offset:14336
    v_mfma_f32_16x16x32_bf16 v[104:107], a[104:107], a[48:51], v[104:107]
    buffer_load_dwordx4 v6, s[8:11], s81 offen offset:1024 lds
    v_mfma_f32_16x16x32_bf16 v[112:115], a[104:107], a[52:55], v[112:115]
    ds_read_b128 a[32:35], v7 offset:16384
    v_add_u32 v6, 86016, v6
    v_mfma_f32_16x16x32_bf16 v[120:123], a[104:107], a[56:59], v[120:123]
    ds_read_b64_tr_b16 a[76:77], v224 offset:0
    v_mfma_f32_16x16x32_bf16 v[128:131], a[104:107], a[60:63], v[128:131]
    s_add_u32 m0, s75, 24576
    v_mfma_f32_16x16x32_bf16 v[136:139], a[104:107], a[64:67], v[136:139]
    ds_read_b64_tr_b16 a[78:79], v225 offset:6144
    buffer_load_dwordx4 v6, s[8:11], s76 offen offset:0 lds
    v_mfma_f32_16x16x32_bf16 v[144:147], a[104:107], a[68:71], v[144:147]
    ds_read_b64_tr_b16 a[80:81], v10 offset:2048
    v_mfma_f32_16x16x32_bf16 v[84:87], a[108:111], a[36:39], v[84:87]
    ds_read_b64_tr_b16 a[82:83], v10 offset:8192
    v_mfma_f32_16x16x32_bf16 v[92:95], a[108:111], a[40:43], v[92:95]
    v_mfma_f32_16x16x32_bf16 v[100:103], a[108:111], a[44:47], v[100:103]
    ds_read_b64_tr_b16 a[84:85], v12 offset:2048
    v_mfma_f32_16x16x32_bf16 v[108:111], a[108:111], a[48:51], v[108:111]
    buffer_load_dwordx4 v6, s[8:11], s77 offen offset:1024 lds
    ds_read_b64_tr_b16 a[86:87], v12 offset:8192
    v_mfma_f32_16x16x32_bf16 v[116:119], a[108:111], a[52:55], v[116:119]
    v_mfma_f32_16x16x32_bf16 v[124:127], a[108:111], a[56:59], v[124:127]
    ds_read_b64_tr_b16 a[88:89], v10 offset:4096
    v_mfma_f32_16x16x32_bf16 v[132:135], a[108:111], a[60:63], v[132:135]
    ds_read_b64_tr_b16 a[90:91], v10 offset:10240
    v_mfma_f32_16x16x32_bf16 v[140:143], a[108:111], a[64:67], v[140:143]
    buffer_load_dwordx4 v6, s[8:11], s78 offen offset:2048 lds
    v_mfma_f32_16x16x32_bf16 v[148:151], a[108:111], a[68:71], v[148:151]
    ds_read_b64_tr_b16 a[92:93], v12 offset:4096
    v_mfma_f32_16x16x32_bf16 v[152:155], a[36:39], a[112:115], v[152:155]
    ds_read_b64_tr_b16 a[94:95], v12 offset:10240
    v_mfma_f32_16x16x32_bf16 v[156:159], a[40:43], a[112:115], v[156:159]
    v_mfma_f32_16x16x32_bf16 v[160:163], a[44:47], a[112:115], v[160:163]
    buffer_load_dwordx4 v6, s[8:11], s79 offen offset:3072 lds
    v_mfma_f32_16x16x32_bf16 v[164:167], a[48:51], a[112:115], v[164:167]
    v_mfma_f32_16x16x32_bf16 v[168:171], a[52:55], a[112:115], v[168:171]
    v_mfma_f32_16x16x32_bf16 v[172:175], a[56:59], a[112:115], v[172:175]
    s_add_u32 m0, s75, 28672
    v_mfma_f32_16x16x32_bf16 v[176:179], a[60:63], a[112:115], v[176:179]
    v_mfma_f32_16x16x32_bf16 v[180:183], a[64:67], a[112:115], v[180:183]
    buffer_load_dwordx4 v6, s[8:11], s80 offen offset:0 lds
    v_mfma_f32_16x16x32_bf16 v[184:187], a[68:71], a[112:115], v[184:187]
    v_mfma_f32_16x16x32_bf16 v[188:191], a[36:39], a[116:119], v[188:191]
    v_mfma_f32_16x16x32_bf16 v[192:195], a[40:43], a[116:119], v[192:195]
    s_cmp_eq_u32 s92, 4
    s_cselect_b32 s93, s99, 86016
    v_mfma_f32_16x16x32_bf16 v[196:199], a[44:47], a[116:119], v[196:199]
    buffer_load_dwordx4 v6, s[8:11], s81 offen offset:1024 lds
    v_mfma_f32_16x16x32_bf16 v[200:203], a[48:51], a[116:119], v[200:203]
    v_add_u32 v6, s93, v6
    v_mfma_f32_16x16x32_bf16 v[204:207], a[52:55], a[116:119], v[204:207]
    v_mfma_f32_16x16x32_bf16 v[208:211], a[56:59], a[116:119], v[208:211]
    s_mov_b32 s82, s87
    s_add_u32 s87, s87, 128
    s_add_u32 m0, s74, 40960
    v_mfma_f32_16x16x32_bf16 v[212:215], a[60:63], a[116:119], v[212:215]
    s_cmp_eq_u32 s92, 5
    s_cselect_b32 s87, 0, s87
    buffer_load_dwordx4 v1, s[4:7], s82 offen offset:0 lds
    v_mfma_f32_16x16x32_bf16 v[216:219], a[64:67], a[116:119], v[216:219]
    v_mfma_f32_16x16x32_bf16 v[220:223], a[68:71], a[116:119], v[220:223]
    s_waitcnt vmcnt(18) lgkmcnt(0)
    s_barrier
    v_mfma_f32_16x16x32_bf16 v[16:19], a[72:75], a[4:7], v[16:19]
    s_add_u32 s83, s3, 4294942976
    v_mfma_f32_16x16x32_bf16 v[24:27], a[72:75], a[8:11], v[24:27]
    s_add_u32 m0, s74, 45056
    v_mad_i32_i24 v224, v15, s83, v14
    v_mfma_f32_16x16x32_bf16 v[32:35], a[72:75], a[12:15], v[32:35]
    s_add_u32 s84, s3, 4294936864
    buffer_load_dwordx4 v2, s[4:7], s82 offen offset:0 lds
    v_mfma_f32_16x16x32_bf16 v[40:43], a[72:75], a[16:19], v[40:43]
    v_mfma_f32_16x16x32_bf16 v[48:51], a[72:75], a[20:23], v[48:51]
    v_mad_i32_i24 v225, v15, s84, v14
    v_mfma_f32_16x16x32_bf16 v[56:59], a[72:75], a[24:27], v[56:59]
    s_add_u32 m0, s74, 49152
    s_add_u32 s3, s3, 512
    v_mfma_f32_16x16x32_bf16 v[64:67], a[72:75], a[28:31], v[64:67]
    s_cmp_eq_u32 s92, 3
    s_cselect_b32 s3, 0, s3
    buffer_load_dwordx4 v3, s[4:7], s82 offen offset:0 lds
    v_mfma_f32_16x16x32_bf16 v[72:75], a[72:75], a[32:35], v[72:75]
    v_mfma_f32_16x16x32_bf16 v[20:23], a[76:79], a[4:7], v[20:23]
    ds_read_b64_tr_b16 a[96:97], v10 offset:24576
    v_mfma_f32_16x16x32_bf16 v[28:31], a[76:79], a[8:11], v[28:31]
    s_add_u32 m0, s74, 53248
    ds_read_b64_tr_b16 a[98:99], v10 offset:30720
    v_mfma_f32_16x16x32_bf16 v[36:39], a[76:79], a[12:15], v[36:39]
    ds_read_b128 a[36:39], v8 offset:0
    buffer_load_dwordx4 v4, s[4:7], s82 offen offset:0 lds
    v_mfma_f32_16x16x32_bf16 v[44:47], a[76:79], a[16:19], v[44:47]
    v_mfma_f32_16x16x32_bf16 v[52:55], a[76:79], a[20:23], v[52:55]
    ds_read_b128 a[40:43], v8 offset:2048
    v_mfma_f32_16x16x32_bf16 v[60:63], a[76:79], a[24:27], v[60:63]
    s_add_u32 m0, s74, 57344
    ds_read_b128 a[44:47], v8 offset:4096
    v_mfma_f32_16x16x32_bf16 v[68:71], a[76:79], a[28:31], v[68:71]
    ds_read_b128 a[48:51], v8 offset:6144
    v_mfma_f32_16x16x32_bf16 v[76:79], a[76:79], a[32:35], v[76:79]
    buffer_load_dwordx4 v5, s[4:7], s82 offen offset:0 lds
    v_mfma_f32_16x16x32_bf16 v[80:83], a[80:83], a[0:3], v[80:83]
    ds_read_b128 a[52:55], v8 offset:8192
    v_mfma_f32_16x16x32_bf16 v[88:91], a[80:83], a[4:7], v[88:91]
    ds_read_b128 a[56:59], v8 offset:10240
    v_mfma_f32_16x16x32_bf16 v[96:99], a[80:83], a[8:11], v[96:99]
    s_add_u32 m0, s75, 49152
    ds_read_b128 a[60:63], v8 offset:12288
    v_mfma_f32_16x16x32_bf16 v[104:107], a[80:83], a[12:15], v[104:107]
    buffer_load_dwordx4 v6, s[8:11], s76 offen offset:0 lds
    v_mfma_f32_16x16x32_bf16 v[112:115], a[80:83], a[16:19], v[112:115]
    ds_read_b128 a[64:67], v8 offset:14336
    v_mfma_f32_16x16x32_bf16 v[120:123], a[80:83], a[20:23], v[120:123]
    ds_read_b128 a[68:71], v8 offset:16384
    v_mfma_f32_16x16x32_bf16 v[128:131], a[80:83], a[24:27], v[128:131]
    ds_read_b64_tr_b16 a[100:101], v224 offset:24576
    v_mfma_f32_16x16x32_bf16 v[136:139], a[80:83], a[28:31], v[136:139]
    buffer_load_dwordx4 v6, s[8:11], s77 offen offset:1024 lds
    v_mfma_f32_16x16x32_bf16 v[144:147], a[80:83], a[32:35], v[144:147]
    ds_read_b64_tr_b16 a[102:103], v225 offset:30720
    v_mfma_f32_16x16x32_bf16 v[84:87], a[84:87], a[0:3], v[84:87]
    ds_read_b64_tr_b16 a[104:105], v10 offset:26624
    v_mfma_f32_16x16x32_bf16 v[92:95], a[84:87], a[4:7], v[92:95]
    ds_read_b64_tr_b16 a[106:107], v10 offset:32768
    v_mfma_f32_16x16x32_bf16 v[100:103], a[84:87], a[8:11], v[100:103]
    v_mfma_f32_16x16x32_bf16 v[108:111], a[84:87], a[12:15], v[108:111]
    ds_read_b64_tr_b16 a[108:109], v12 offset:26624
    buffer_load_dwordx4 v6, s[8:11], s78 offen offset:2048 lds
    v_mfma_f32_16x16x32_bf16 v[116:119], a[84:87], a[16:19], v[116:119]
    ds_read_b64_tr_b16 a[110:111], v12 offset:32768
    v_mfma_f32_16x16x32_bf16 v[124:127], a[84:87], a[20:23], v[124:127]
    ds_read_b64_tr_b16 a[112:113], v10 offset:28672
    v_mfma_f32_16x16x32_bf16 v[132:135], a[84:87], a[24:27], v[132:135]
    v_mfma_f32_16x16x32_bf16 v[140:143], a[84:87], a[28:31], v[140:143]
    ds_read_b64_tr_b16 a[114:115], v10 offset:34816
    buffer_load_dwordx4 v6, s[8:11], s79 offen offset:3072 lds
    v_mfma_f32_16x16x32_bf16 v[148:151], a[84:87], a[32:35], v[148:151]
    ds_read_b64_tr_b16 a[116:117], v12 offset:28672
    v_mfma_f32_16x16x32_bf16 v[152:155], a[0:3], a[88:91], v[152:155]
    ds_read_b64_tr_b16 a[118:119], v12 offset:34816
    v_mfma_f32_16x16x32_bf16 v[156:159], a[4:7], a[88:91], v[156:159]
    s_add_u32 m0, s75, 53248
    v_mfma_f32_16x16x32_bf16 v[160:163], a[8:11], a[88:91], v[160:163]
    buffer_load_dwordx4 v6, s[8:11], s80 offen offset:0 lds
    v_mfma_f32_16x16x32_bf16 v[164:167], a[12:15], a[88:91], v[164:167]
    v_mfma_f32_16x16x32_bf16 v[168:171], a[16:19], a[88:91], v[168:171]
    v_mfma_f32_16x16x32_bf16 v[172:175], a[20:23], a[88:91], v[172:175]
    v_mfma_f32_16x16x32_bf16 v[176:179], a[24:27], a[88:91], v[176:179]
    v_mfma_f32_16x16x32_bf16 v[180:183], a[28:31], a[88:91], v[180:183]
    buffer_load_dwordx4 v6, s[8:11], s81 offen offset:1024 lds
    v_mfma_f32_16x16x32_bf16 v[184:187], a[32:35], a[88:91], v[184:187]
    v_add_u32 v6, 86016, v6
    v_mfma_f32_16x16x32_bf16 v[188:191], a[0:3], a[92:95], v[188:191]
    v_mfma_f32_16x16x32_bf16 v[192:195], a[4:7], a[92:95], v[192:195]
    v_mfma_f32_16x16x32_bf16 v[196:199], a[8:11], a[92:95], v[196:199]
    v_mfma_f32_16x16x32_bf16 v[200:203], a[12:15], a[92:95], v[200:203]
    v_mfma_f32_16x16x32_bf16 v[204:207], a[16:19], a[92:95], v[204:207]
    v_mfma_f32_16x16x32_bf16 v[208:211], a[20:23], a[92:95], v[208:211]
    v_mfma_f32_16x16x32_bf16 v[212:215], a[24:27], a[92:95], v[212:215]
    v_mfma_f32_16x16x32_bf16 v[216:219], a[28:31], a[92:95], v[216:219]
    v_mfma_f32_16x16x32_bf16 v[220:223], a[32:35], a[92:95], v[220:223]
    s_waitcnt vmcnt(17) lgkmcnt(0)
    s_barrier
    v_mfma_f32_16x16x32_bf16 v[16:19], a[96:99], a[40:43], v[16:19]
    s_add_u32 s83, s3, 0
    v_mfma_f32_16x16x32_bf16 v[24:27], a[96:99], a[44:47], v[24:27]
    s_add_u32 m0, s75, 73728
    v_mad_i32_i24 v224, v15, s83, v13
    v_mfma_f32_16x16x32_bf16 v[32:35], a[96:99], a[48:51], v[32:35]
    s_add_u32 s84, s3, 4294961184
    buffer_load_dwordx4 v6, s[8:11], s76 offen offset:0 lds
    v_mfma_f32_16x16x32_bf16 v[40:43], a[96:99], a[52:55], v[40:43]
    v_mfma_f32_16x16x32_bf16 v[48:51], a[96:99], a[56:59], v[48:51]
    v_mad_i32_i24 v225, v15, s84, v13
    v_mfma_f32_16x16x32_bf16 v[56:59], a[96:99], a[60:63], v[56:59]
    ds_read_b64_tr_b16 a[72:73], v9 offset:0
    v_mfma_f32_16x16x32_bf16 v[64:67], a[96:99], a[64:67], v[64:67]
    buffer_load_dwordx4 v6, s[8:11], s77 offen offset:1024 lds
    v_mfma_f32_16x16x32_bf16 v[72:75], a[96:99], a[68:71], v[72:75]
    ds_read_b64_tr_b16 a[74:75], v9 offset:6144
    v_mfma_f32_16x16x32_bf16 v[20:23], a[100:103], a[40:43], v[20:23]
    ds_read_b128 a[0:3], v7 offset:20480
    v_mfma_f32_16x16x32_bf16 v[28:31], a[100:103], a[44:47], v[28:31]
    v_mfma_f32_16x16x32_bf16 v[36:39], a[100:103], a[48:51], v[36:39]
    ds_read_b128 a[4:7], v7 offset:22528
    buffer_load_dwordx4 v6, s[8:11], s78 offen offset:2048 lds
    v_mfma_f32_16x16x32_bf16 v[44:47], a[100:103], a[52:55], v[44:47]
    ds_read_b128 a[8:11], v7 offset:24576
    v_mfma_f32_16x16x32_bf16 v[52:55], a[100:103], a[56:59], v[52:55]
    ds_read_b128 a[12:15], v7 offset:26624
    v_mfma_f32_16x16x32_bf16 v[60:63], a[100:103], a[60:63], v[60:63]
    v_mfma_f32_16x16x32_bf16 v[68:71], a[100:103], a[64:67], v[68:71]
    ds_read_b128 a[16:19], v7 offset:28672
    v_mfma_f32_16x16x32_bf16 v[76:79], a[100:103], a[68:71], v[76:79]
    buffer_load_dwordx4 v6, s[8:11], s79 offen offset:3072 lds
    ds_read_b128 a[20:23], v7 offset:30720
    v_mfma_f32_16x16x32_bf16 v[80:83], a[104:107], a[36:39], v[80:83]
    v_mfma_f32_16x16x32_bf16 v[88:91], a[104:107], a[40:43], v[88:91]
    ds_read_b128 a[24:27], v7 offset:32768
    v_mfma_f32_16x16x32_bf16 v[96:99], a[104:107], a[44:47], v[96:99]
    s_add_u32 m0, s75, 77824
    ds_read_b128 a[28:31], v7 offset:34816
    v_mfma_f32_16x16x32_bf16 v[104:107], a[104:107], a[48:51], v[104:107]
    buffer_load_dwordx4 v6, s[8:11], s80 offen offset:0 lds
    v_mfma_f32_16x16x32_bf16 v[112:115], a[104:107], a[52:55], v[112:115]
    ds_read_b128 a[32:35], v7 offset:36864
    v_mfma_f32_16x16x32_bf16 v[120:123], a[104:107], a[56:59], v[120:123]
    ds_read_b64_tr_b16 a[76:77], v224 offset:0
    v_mfma_f32_16x16x32_bf16 v[128:131], a[104:107], a[60:63], v[128:131]
    s_cmp_eq_u32 s92, 5
    s_cselect_b32 s93, s99, 86016
    v_mfma_f32_16x16x32_bf16 v[136:139], a[104:107], a[64:67], v[136:139]
    ds_read_b64_tr_b16 a[78:79], v225 offset:6144
    buffer_load_dwordx4 v6, s[8:11], s81 offen offset:1024 lds
    v_mfma_f32_16x16x32_bf16 v[144:147], a[104:107], a[68:71], v[144:147]
    ds_read_b64_tr_b16 a[80:81], v9 offset:2048
    v_add_u32 v6, s93, v6
    v_mfma_f32_16x16x32_bf16 v[84:87], a[108:111], a[36:39], v[84:87]
    ds_read_b64_tr_b16 a[82:83], v9 offset:8192
    v_mfma_f32_16x16x32_bf16 v[92:95], a[108:111], a[40:43], v[92:95]
    s_mov_b32 s82, s87
    s_add_u32 s87, s87, 128
    s_add_u32 m0, s74, 0
    v_mfma_f32_16x16x32_bf16 v[100:103], a[108:111], a[44:47], v[100:103]
    s_cmp_eq_u32 s92, 6
    s_cselect_b32 s87, 0, s87
    ds_read_b64_tr_b16 a[84:85], v11 offset:2048
    v_mfma_f32_16x16x32_bf16 v[108:111], a[108:111], a[48:51], v[108:111]
    buffer_load_dwordx4 v1, s[4:7], s82 offen offset:0 lds
    ds_read_b64_tr_b16 a[86:87], v11 offset:8192
    v_mfma_f32_16x16x32_bf16 v[116:119], a[108:111], a[52:55], v[116:119]
    v_mfma_f32_16x16x32_bf16 v[124:127], a[108:111], a[56:59], v[124:127]
    ds_read_b64_tr_b16 a[88:89], v9 offset:4096
    v_mfma_f32_16x16x32_bf16 v[132:135], a[108:111], a[60:63], v[132:135]
    s_add_u32 m0, s74, 4096
    ds_read_b64_tr_b16 a[90:91], v9 offset:10240
    v_mfma_f32_16x16x32_bf16 v[140:143], a[108:111], a[64:67], v[140:143]
    buffer_load_dwordx4 v2, s[4:7], s82 offen offset:0 lds
    v_mfma_f32_16x16x32_bf16 v[148:151], a[108:111], a[68:71], v[148:151]
    ds_read_b64_tr_b16 a[92:93], v11 offset:4096
    v_mfma_f32_16x16x32_bf16 v[152:155], a[36:39], a[112:115], v[152:155]
    ds_read_b64_tr_b16 a[94:95], v11 offset:10240
    v_mfma_f32_16x16x32_bf16 v[156:159], a[40:43], a[112:115], v[156:159]
    s_add_u32 m0, s74, 8192
    v_mfma_f32_16x16x32_bf16 v[160:163], a[44:47], a[112:115], v[160:163]
    buffer_load_dwordx4 v3, s[4:7], s82 offen offset:0 lds
    v_mfma_f32_16x16x32_bf16 v[164:167], a[48:51], a[112:115], v[164:167]
    v_mfma_f32_16x16x32_bf16 v[168:171], a[52:55], a[112:115], v[168:171]
    v_mfma_f32_16x16x32_bf16 v[172:175], a[56:59], a[112:115], v[172:175]
    s_add_u32 m0, s74, 12288
    v_mfma_f32_16x16x32_bf16 v[176:179], a[60:63], a[112:115], v[176:179]
    v_mfma_f32_16x16x32_bf16 v[180:183], a[64:67], a[112:115], v[180:183]
    buffer_load_dwordx4 v4, s[4:7], s82 offen offset:0 lds
    v_mfma_f32_16x16x32_bf16 v[184:187], a[68:71], a[112:115], v[184:187]
    v_mfma_f32_16x16x32_bf16 v[188:191], a[36:39], a[116:119], v[188:191]
    v_mfma_f32_16x16x32_bf16 v[192:195], a[40:43], a[116:119], v[192:195]
    s_add_u32 m0, s74, 16384
    v_mfma_f32_16x16x32_bf16 v[196:199], a[44:47], a[116:119], v[196:199]
    buffer_load_dwordx4 v5, s[4:7], s82 offen offset:0 lds
    v_mfma_f32_16x16x32_bf16 v[200:203], a[48:51], a[116:119], v[200:203]
    v_mfma_f32_16x16x32_bf16 v[204:207], a[52:55], a[116:119], v[204:207]
    v_mfma_f32_16x16x32_bf16 v[208:211], a[56:59], a[116:119], v[208:211]
    v_mfma_f32_16x16x32_bf16 v[212:215], a[60:63], a[116:119], v[212:215]
    v_mfma_f32_16x16x32_bf16 v[216:219], a[64:67], a[116:119], v[216:219]
    v_mfma_f32_16x16x32_bf16 v[220:223], a[68:71], a[116:119], v[220:223]
    s_waitcnt vmcnt(22) lgkmcnt(0)
    s_barrier
    v_mfma_f32_16x16x32_bf16 v[16:19], a[72:75], a[4:7], v[16:19]
    s_add_u32 s83, s3, 4294942976
    v_mfma_f32_16x16x32_bf16 v[24:27], a[72:75], a[8:11], v[24:27]
    s_add_u32 m0, s75, 0
    v_mad_i32_i24 v224, v15, s83, v13
    v_mfma_f32_16x16x32_bf16 v[32:35], a[72:75], a[12:15], v[32:35]
    s_add_u32 s84, s3, 4294936864
    buffer_load_dwordx4 v6, s[8:11], s76 offen offset:0 lds
    v_mfma_f32_16x16x32_bf16 v[40:43], a[72:75], a[16:19], v[40:43]
    v_mfma_f32_16x16x32_bf16 v[48:51], a[72:75], a[20:23], v[48:51]
    v_mad_i32_i24 v225, v15, s84, v13
    v_mfma_f32_16x16x32_bf16 v[56:59], a[72:75], a[24:27], v[56:59]
    s_add_u32 s3, s3, 512
    v_mfma_f32_16x16x32_bf16 v[64:67], a[72:75], a[28:31], v[64:67]
    s_cmp_eq_u32 s92, 4
    s_cselect_b32 s3, 0, s3
    buffer_load_dwordx4 v6, s[8:11], s77 offen offset:1024 lds
    v_mfma_f32_16x16x32_bf16 v[72:75], a[72:75], a[32:35], v[72:75]
    v_mfma_f32_16x16x32_bf16 v[20:23], a[76:79], a[4:7], v[20:23]
    ds_read_b64_tr_b16 a[96:97], v9 offset:24576
    v_mfma_f32_16x16x32_bf16 v[28:31], a[76:79], a[8:11], v[28:31]
    ds_read_b64_tr_b16 a[98:99], v9 offset:30720
    v_mfma_f32_16x16x32_bf16 v[36:39], a[76:79], a[12:15], v[36:39]
    ds_read_b128 a[36:39], v8 offset:20480
    buffer_load_dwordx4 v6, s[8:11], s78 offen offset:2048 lds
    v_mfma_f32_16x16x32_bf16 v[44:47], a[76:79], a[16:19], v[44:47]
    v_mfma_f32_16x16x32_bf16 v[52:55], a[76:79], a[20:23], v[52:55]
    ds_read_b128 a[40:43], v8 offset:22528
    v_mfma_f32_16x16x32_bf16 v[60:63], a[76:79], a[24:27], v[60:63]
    ds_read_b128 a[44:47], v8 offset:24576
    v_mfma_f32_16x16x32_bf16 v[68:71], a[76:79], a[28:31], v[68:71]
    ds_read_b128 a[48:51], v8 offset:26624
    v_mfma_f32_16x16x32_bf16 v[76:79], a[76:79], a[32:35], v[76:79]
    buffer_load_dwordx4 v6, s[8:11], s79 offen offset:3072 lds
    v_mfma_f32_16x16x32_bf16 v[80:83], a[80:83], a[0:3], v[80:83]
    ds_read_b128 a[52:55], v8 offset:28672
    v_mfma_f32_16x16x32_bf16 v[88:91], a[80:83], a[4:7], v[88:91]
    ds_read_b128 a[56:59], v8 offset:30720
    v_mfma_f32_16x16x32_bf16 v[96:99], a[80:83], a[8:11], v[96:99]
    s_add_u32 m0, s75, 4096
    ds_read_b128 a[60:63], v8 offset:32768
    v_mfma_f32_16x16x32_bf16 v[104:107], a[80:83], a[12:15], v[104:107]
    buffer_load_dwordx4 v6, s[8:11], s80 offen offset:0 lds
    v_mfma_f32_16x16x32_bf16 v[112:115], a[80:83], a[16:19], v[112:115]
    ds_read_b128 a[64:67], v8 offset:34816
    v_mfma_f32_16x16x32_bf16 v[120:123], a[80:83], a[20:23], v[120:123]
    ds_read_b128 a[68:71], v8 offset:36864
    v_mfma_f32_16x16x32_bf16 v[128:131], a[80:83], a[24:27], v[128:131]
    ds_read_b64_tr_b16 a[100:101], v224 offset:24576
    v_mfma_f32_16x16x32_bf16 v[136:139], a[80:83], a[28:31], v[136:139]
    buffer_load_dwordx4 v6, s[8:11], s81 offen offset:1024 lds
    v_mfma_f32_16x16x32_bf16 v[144:147], a[80:83], a[32:35], v[144:147]
    ds_read_b64_tr_b16 a[102:103], v225 offset:30720
    v_add_u32 v6, 86016, v6
    v_mfma_f32_16x16x32_bf16 v[84:87], a[84:87], a[0:3], v[84:87]
    ds_read_b64_tr_b16 a[104:105], v9 offset:26624
    v_mov_b32 v249, 0
    v_mfma_f32_16x16x32_bf16 v[92:95], a[84:87], a[4:7], v[92:95]
    ds_read_b64_tr_b16 a[106:107], v9 offset:32768
    v_mfma_f32_16x16x32_bf16 v[100:103], a[84:87], a[8:11], v[100:103]
    v_mfma_f32_16x16x32_bf16 v[108:111], a[84:87], a[12:15], v[108:111]
    ds_read_b64_tr_b16 a[108:109], v11 offset:26624
    buffer_load_dword v248, v249, s[32:35], 0 offen sc1
    v_mfma_f32_16x16x32_bf16 v[116:119], a[84:87], a[16:19], v[116:119]
    ds_read_b64_tr_b16 a[110:111], v11 offset:32768
    v_mfma_f32_16x16x32_bf16 v[124:127], a[84:87], a[20:23], v[124:127]
    ds_read_b64_tr_b16 a[112:113], v9 offset:28672
    v_mfma_f32_16x16x32_bf16 v[132:135], a[84:87], a[24:27], v[132:135]
    v_mfma_f32_16x16x32_bf16 v[140:143], a[84:87], a[28:31], v[140:143]
    ds_read_b64_tr_b16 a[114:115], v9 offset:34816
    v_mfma_f32_16x16x32_bf16 v[148:151], a[84:87], a[32:35], v[148:151]
    ds_read_b64_tr_b16 a[116:117], v11 offset:28672
    v_mfma_f32_16x16x32_bf16 v[152:155], a[0:3], a[88:91], v[152:155]
    ds_read_b64_tr_b16 a[118:119], v11 offset:34816
    v_mfma_f32_16x16x32_bf16 v[156:159], a[4:7], a[88:91], v[156:159]
    v_mfma_f32_16x16x32_bf16 v[160:163], a[8:11], a[88:91], v[160:163]
    v_mfma_f32_16x16x32_bf16 v[164:167], a[12:15], a[88:91], v[164:167]
    v_mfma_f32_16x16x32_bf16 v[168:171], a[16:19], a[88:91], v[168:171]
    v_mfma_f32_16x16x32_bf16 v[172:175], a[20:23], a[88:91], v[172:175]
    v_mfma_f32_16x16x32_bf16 v[176:179], a[24:27], a[88:91], v[176:179]
    v_mfma_f32_16x16x32_bf16 v[180:183], a[28:31], a[88:91], v[180:183]
    v_mfma_f32_16x16x32_bf16 v[184:187], a[32:35], a[88:91], v[184:187]
    v_mfma_f32_16x16x32_bf16 v[188:191], a[0:3], a[92:95], v[188:191]
    v_mfma_f32_16x16x32_bf16 v[192:195], a[4:7], a[92:95], v[192:195]
    v_mfma_f32_16x16x32_bf16 v[196:199], a[8:11], a[92:95], v[196:199]
    v_mfma_f32_16x16x32_bf16 v[200:203], a[12:15], a[92:95], v[200:203]
    v_mfma_f32_16x16x32_bf16 v[204:207], a[16:19], a[92:95], v[204:207]
    v_mfma_f32_16x16x32_bf16 v[208:211], a[20:23], a[92:95], v[208:211]
    v_mfma_f32_16x16x32_bf16 v[212:215], a[24:27], a[92:95], v[212:215]
    v_mfma_f32_16x16x32_bf16 v[216:219], a[28:31], a[92:95], v[216:219]
    v_mfma_f32_16x16x32_bf16 v[220:223], a[32:35], a[92:95], v[220:223]
    s_waitcnt vmcnt(18) lgkmcnt(0)
    s_barrier
    v_mfma_f32_16x16x32_bf16 v[16:19], a[96:99], a[40:43], v[16:19]
    s_add_u32 s83, s3, 0
    v_mfma_f32_16x16x32_bf16 v[24:27], a[96:99], a[44:47], v[24:27]
    s_add_u32 m0, s75, 24576
    v_mad_i32_i24 v224, v15, s83, v14
    v_mfma_f32_16x16x32_bf16 v[32:35], a[96:99], a[48:51], v[32:35]
    s_add_u32 s84, s3, 4294961184
    buffer_load_dwordx4 v6, s[8:11], s76 offen offset:0 lds
    v_mfma_f32_16x16x32_bf16 v[40:43], a[96:99], a[52:55], v[40:43]
    v_mfma_f32_16x16x32_bf16 v[48:51], a[96:99], a[56:59], v[48:51]
    v_mad_i32_i24 v225, v15, s84, v14
    v_mfma_f32_16x16x32_bf16 v[56:59], a[96:99], a[60:63], v[56:59]
    ds_read_b64_tr_b16 a[72:73], v10 offset:0
    v_mfma_f32_16x16x32_bf16 v[64:67], a[96:99], a[64:67], v[64:67]
    buffer_load_dwordx4 v6, s[8:11], s77 offen offset:1024 lds
    v_mfma_f32_16x16x32_bf16 v[72:75], a[96:99], a[68:71], v[72:75]
    ds_read_b64_tr_b16 a[74:75], v10 offset:6144
    v_mfma_f32_16x16x32_bf16 v[20:23], a[100:103], a[40:43], v[20:23]
    ds_read_b128 a[0:3], v7 offset:40960
    v_mfma_f32_16x16x32_bf16 v[28:31], a[100:103], a[44:47], v[28:31]
    v_mfma_f32_16x16x32_bf16 v[36:39], a[100:103], a[48:51], v[36:39]
    ds_read_b128 a[4:7], v7 offset:43008
    buffer_load_dwordx4 v6, s[8:11], s78 offen offset:2048 lds
    v_mfma_f32_16x16x32_bf16 v[44:47], a[100:103], a[52:55], v[44:47]
    ds_read_b128 a[8:11], v7 offset:45056
    v_mfma_f32_16x16x32_bf16 v[52:55], a[100:103], a[56:59], v[52:55]
    ds_read_b128 a[12:15], v7 offset:47104
    v_mfma_f32_16x16x32_bf16 v[60:63], a[100:103], a[60:63], v[60:63]
    v_mfma_f32_16x16x32_bf16 v[68:71], a[100:103], a[64:67], v[68:71]
    ds_read_b128 a[16:19], v7 offset:49152
    v_mfma_f32_16x16x32_bf16 v[76:79], a[100:103], a[68:71], v[76:79]
    buffer_load_dwordx4 v6, s[8:11], s79 offen offset:3072 lds
    ds_read_b128 a[20:23], v7 offset:51200
    v_mfma_f32_16x16x32_bf16 v[80:83], a[104:107], a[36:39], v[80:83]
    v_mfma_f32_16x16x32_bf16 v[88:91], a[104:107], a[40:43], v[88:91]
    ds_read_b128 a[24:27], v7 offset:53248
    v_mfma_f32_16x16x32_bf16 v[96:99], a[104:107], a[44:47], v[96:99]
    s_add_u32 m0, s75, 28672
    ds_read_b128 a[28:31], v7 offset:55296
    v_mfma_f32_16x16x32_bf16 v[104:107], a[104:107], a[48:51], v[104:107]
    buffer_load_dwordx4 v6, s[8:11], s80 offen offset:0 lds
    v_mfma_f32_16x16x32_bf16 v[112:115], a[104:107], a[52:55], v[112:115]
    ds_read_b128 a[32:35], v7 offset:57344
    v_mfma_f32_16x16x32_bf16 v[120:123], a[104:107], a[56:59], v[120:123]
    ds_read_b64_tr_b16 a[76:77], v224 offset:0
    v_mfma_f32_16x16x32_bf16 v[128:131], a[104:107], a[60:63], v[128:131]
    s_cmp_eq_u32 s92, 6
    s_cselect_b32 s93, s99, 86016
    v_mfma_f32_16x16x32_bf16 v[136:139], a[104:107], a[64:67], v[136:139]
    ds_read_b64_tr_b16 a[78:79], v225 offset:6144
    buffer_load_dwordx4 v6, s[8:11], s81 offen offset:1024 lds
    v_mfma_f32_16x16x32_bf16 v[144:147], a[104:107], a[68:71], v[144:147]
    ds_read_b64_tr_b16 a[80:81], v10 offset:2048
    v_add_u32 v6, s93, v6
    v_mfma_f32_16x16x32_bf16 v[84:87], a[108:111], a[36:39], v[84:87]
    ds_read_b64_tr_b16 a[82:83], v10 offset:8192
    v_mfma_f32_16x16x32_bf16 v[92:95], a[108:111], a[40:43], v[92:95]
    v_mfma_f32_16x16x32_bf16 v[100:103], a[108:111], a[44:47], v[100:103]
    ds_read_b64_tr_b16 a[84:85], v12 offset:2048
    v_mfma_f32_16x16x32_bf16 v[108:111], a[108:111], a[48:51], v[108:111]
    ds_read_b64_tr_b16 a[86:87], v12 offset:8192
    v_mfma_f32_16x16x32_bf16 v[116:119], a[108:111], a[52:55], v[116:119]
    v_mfma_f32_16x16x32_bf16 v[124:127], a[108:111], a[56:59], v[124:127]
    ds_read_b64_tr_b16 a[88:89], v10 offset:4096
    v_mfma_f32_16x16x32_bf16 v[132:135], a[108:111], a[60:63], v[132:135]
    ds_read_b64_tr_b16 a[90:91], v10 offset:10240
    v_mfma_f32_16x16x32_bf16 v[140:143], a[108:111], a[64:67], v[140:143]
    v_mfma_f32_16x16x32_bf16 v[148:151], a[108:111], a[68:71], v[148:151]
    ds_read_b64_tr_b16 a[92:93], v12 offset:4096
    v_mfma_f32_16x16x32_bf16 v[152:155], a[36:39], a[112:115], v[152:155]
    ds_read_b64_tr_b16 a[94:95], v12 offset:10240
    v_mfma_f32_16x16x32_bf16 v[156:159], a[40:43], a[112:115], v[156:159]
    v_mfma_f32_16x16x32_bf16 v[160:163], a[44:47], a[112:115], v[160:163]
    v_mfma_f32_16x16x32_bf16 v[164:167], a[48:51], a[112:115], v[164:167]
    v_mfma_f32_16x16x32_bf16 v[168:171], a[52:55], a[112:115], v[168:171]
    v_mfma_f32_16x16x32_bf16 v[172:175], a[56:59], a[112:115], v[172:175]
    v_mfma_f32_16x16x32_bf16 v[176:179], a[60:63], a[112:115], v[176:179]
    v_mfma_f32_16x16x32_bf16 v[180:183], a[64:67], a[112:115], v[180:183]
    v_mfma_f32_16x16x32_bf16 v[184:187], a[68:71], a[112:115], v[184:187]
    v_mfma_f32_16x16x32_bf16 v[188:191], a[36:39], a[116:119], v[188:191]
    v_mfma_f32_16x16x32_bf16 v[192:195], a[40:43], a[116:119], v[192:195]
    v_mfma_f32_16x16x32_bf16 v[196:199], a[44:47], a[116:119], v[196:199]
    v_mfma_f32_16x16x32_bf16 v[200:203], a[48:51], a[116:119], v[200:203]
    v_mfma_f32_16x16x32_bf16 v[204:207], a[52:55], a[116:119], v[204:207]
    v_mfma_f32_16x16x32_bf16 v[208:211], a[56:59], a[116:119], v[208:211]
    v_mfma_f32_16x16x32_bf16 v[212:215], a[60:63], a[116:119], v[212:215]
    v_mfma_f32_16x16x32_bf16 v[216:219], a[64:67], a[116:119], v[216:219]
    v_mfma_f32_16x16x32_bf16 v[220:223], a[68:71], a[116:119], v[220:223]
    s_waitcnt vmcnt(18) lgkmcnt(0)
    s_barrier
    v_mfma_f32_16x16x32_bf16 v[16:19], a[72:75], a[4:7], v[16:19]
    s_add_u32 s83, s3, 4294942976
    v_mfma_f32_16x16x32_bf16 v[24:27], a[72:75], a[8:11], v[24:27]
    v_mad_i32_i24 v224, v15, s83, v14
    v_mfma_f32_16x16x32_bf16 v[32:35], a[72:75], a[12:15], v[32:35]
    s_add_u32 s84, s3, 4294936864
    buffer_load_dword a120, v226, s[20:23], 0 offen
    v_mfma_f32_16x16x32_bf16 v[40:43], a[72:75], a[16:19], v[40:43]
    v_mfma_f32_16x16x32_bf16 v[48:51], a[72:75], a[20:23], v[48:51]
    v_mad_i32_i24 v225, v15, s84, v14
    v_mfma_f32_16x16x32_bf16 v[56:59], a[72:75], a[24:27], v[56:59]
    s_add_u32 s3, s3, 512
    v_mfma_f32_16x16x32_bf16 v[64:67], a[72:75], a[28:31], v[64:67]
    s_cmp_eq_u32 s92, 5
    s_cselect_b32 s3, 0, s3
    buffer_load_dword a121, v226, s[20:23], s36 offen
    v_mfma_f32_16x16x32_bf16 v[72:75], a[72:75], a[32:35], v[72:75]
    v_mfma_f32_16x16x32_bf16 v[20:23], a[76:79], a[4:7], v[20:23]
    ds_read_b64_tr_b16 a[96:97], v10 offset:24576
    v_mfma_f32_16x16x32_bf16 v[28:31], a[76:79], a[8:11], v[28:31]
    ds_read_b64_tr_b16 a[98:99], v10 offset:30720
    v_mfma_f32_16x16x32_bf16 v[36:39], a[76:79], a[12:15], v[36:39]
    ds_read_b128 a[36:39], v8 offset:40960
    v_mfma_f32_16x16x32_bf16 v[44:47], a[76:79], a[16:19], v[44:47]
    v_mfma_f32_16x16x32_bf16 v[52:55], a[76:79], a[20:23], v[52:55]
    ds_read_b128 a[40:43], v8 offset:43008
    v_mfma_f32_16x16x32_bf16 v[60:63], a[76:79], a[24:27], v[60:63]
    ds_read_b128 a[44:47], v8 offset:45056
    v_mfma_f32_16x16x32_bf16 v[68:71], a[76:79], a[28:31], v[68:71]
    ds_read_b128 a[48:51], v8 offset:47104
    v_mfma_f32_16x16x32_bf16 v[76:79], a[76:79], a[32:35], v[76:79]
    v_mfma_f32_16x16x32_bf16 v[80:83], a[80:83], a[0:3], v[80:83]
    ds_read_b128 a[52:55], v8 offset:49152
    v_mfma_f32_16x16x32_bf16 v[88:91], a[80:83], a[4:7], v[88:91]
    ds_read_b128 a[56:59], v8 offset:51200
    v_mfma_f32_16x16x32_bf16 v[96:99], a[80:83], a[8:11], v[96:99]
    ds_read_b128 a[60:63], v8 offset:53248
    v_mfma_f32_16x16x32_bf16 v[104:107], a[80:83], a[12:15], v[104:107]
    v_mfma_f32_16x16x32_bf16 v[112:115], a[80:83], a[16:19], v[112:115]
    ds_read_b128 a[64:67], v8 offset:55296
    v_mfma_f32_16x16x32_bf16 v[120:123], a[80:83], a[20:23], v[120:123]
    ds_read_b128 a[68:71], v8 offset:57344
    v_mfma_f32_16x16x32_bf16 v[128:131], a[80:83], a[24:27], v[128:131]
    ds_read_b64_tr_b16 a[100:101], v224 offset:24576
    v_mfma_f32_16x16x32_bf16 v[136:139], a[80:83], a[28:31], v[136:139]
    v_mfma_f32_16x16x32_bf16 v[144:147], a[80:83], a[32:35], v[144:147]
    ds_read_b64_tr_b16 a[102:103], v225 offset:30720
    v_mfma_f32_16x16x32_bf16 v[84:87], a[84:87], a[0:3], v[84:87]
    ds_read_b64_tr_b16 a[104:105], v10 offset:26624
    v_mfma_f32_16x16x32_bf16 v[92:95], a[84:87], a[4:7], v[92:95]
    ds_read_b64_tr_b16 a[106:107], v10 offset:32768
    v_mfma_f32_16x16x32_bf16 v[100:103], a[84:87], a[8:11], v[100:103]
    v_mfma_f32_16x16x32_bf16 v[108:111], a[84:87], a[12:15], v[108:111]
    ds_read_b64_tr_b16 a[108:109], v12 offset:26624
    v_mfma_f32_16x16x32_bf16 v[116:119], a[84:87], a[16:19], v[116:119]
    ds_read_b64_tr_b16 a[110:111], v12 offset:32768
    v_mfma_f32_16x16x32_bf16 v[124:127], a[84:87], a[20:23], v[124:127]
    ds_read_b64_tr_b16 a[112:113], v10 offset:28672
    v_mfma_f32_16x16x32_bf16 v[132:135], a[84:87], a[24:27], v[132:135]
    v_mfma_f32_16x16x32_bf16 v[140:143], a[84:87], a[28:31], v[140:143]
    ds_read_b64_tr_b16 a[114:115], v10 offset:34816
    v_mfma_f32_16x16x32_bf16 v[148:151], a[84:87], a[32:35], v[148:151]
    ds_read_b64_tr_b16 a[116:117], v12 offset:28672
    v_mfma_f32_16x16x32_bf16 v[152:155], a[0:3], a[88:91], v[152:155]
    ds_read_b64_tr_b16 a[118:119], v12 offset:34816
    v_mfma_f32_16x16x32_bf16 v[156:159], a[4:7], a[88:91], v[156:159]
    v_mfma_f32_16x16x32_bf16 v[160:163], a[8:11], a[88:91], v[160:163]
    v_mfma_f32_16x16x32_bf16 v[164:167], a[12:15], a[88:91], v[164:167]
    v_mfma_f32_16x16x32_bf16 v[168:171], a[16:19], a[88:91], v[168:171]
    v_mfma_f32_16x16x32_bf16 v[172:175], a[20:23], a[88:91], v[172:175]
    v_mfma_f32_16x16x32_bf16 v[176:179], a[24:27], a[88:91], v[176:179]
    v_mfma_f32_16x16x32_bf16 v[180:183], a[28:31], a[88:91], v[180:183]
    v_mfma_f32_16x16x32_bf16 v[184:187], a[32:35], a[88:91], v[184:187]
    v_mfma_f32_16x16x32_bf16 v[188:191], a[0:3], a[92:95], v[188:191]
    v_mfma_f32_16x16x32_bf16 v[192:195], a[4:7], a[92:95], v[192:195]
    v_mfma_f32_16x16x32_bf16 v[196:199], a[8:11], a[92:95], v[196:199]
    v_mfma_f32_16x16x32_bf16 v[200:203], a[12:15], a[92:95], v[200:203]
    v_mfma_f32_16x16x32_bf16 v[204:207], a[16:19], a[92:95], v[204:207]
    v_mfma_f32_16x16x32_bf16 v[208:211], a[20:23], a[92:95], v[208:211]
    v_mfma_f32_16x16x32_bf16 v[212:215], a[24:27], a[92:95], v[212:215]
    v_mfma_f32_16x16x32_bf16 v[216:219], a[28:31], a[92:95], v[216:219]
    v_mfma_f32_16x16x32_bf16 v[220:223], a[32:35], a[92:95], v[220:223]
    s_waitcnt vmcnt(9) lgkmcnt(0)
    s_barrier
    v_mfma_f32_16x16x32_bf16 v[16:19], a[96:99], a[40:43], v[16:19]
    s_add_u32 s83, s3, 0
    v_lshrrev_b32 v232, 4, v0
    v_and_b32 v233, 15, v0
    v_mfma_f32_16x16x32_bf16 v[24:27], a[96:99], a[44:47], v[24:27]
    s_mov_b32 s86, 0x3e8b97f6
    v_mad_i32_i24 v224, v15, s83, v13
    v_and_b32 v234, 1, v233
    v_mfma_f32_16x16x32_bf16 v[32:35], a[96:99], a[48:51], v[32:35]
    s_add_u32 s84, s3, 4294961184
    v_cmp_eq_u32 s[88:89], 0, v234
    v_lshl_add_u32 v235, v232, 2, v234
    v_mfma_f32_16x16x32_bf16 v[40:43], a[96:99], a[52:55], v[40:43]
    s_mov_b32 s82, 0x3fb8aa3b
    v_cmp_le_u32 s[90:91], v235, v233
    v_add_u32 v235, 2, v235
    v_mfma_f32_16x16x32_bf16 v[48:51], a[96:99], a[56:59], v[48:51]
    s_lshl_b32 s66, s73, 2
    v_mad_i32_i24 v225, v15, s84, v13
    v_cmp_le_u32 s[100:101], v235, v233
    v_mfma_f32_16x16x32_bf16 v[56:59], a[96:99], a[60:63], v[56:59]
    s_add_u32 s66, s66, s62
    ds_read_b64_tr_b16 a[72:73], v9 offset:0
    v_mov_b32 v236, 0xffff0000
    v_mfma_f32_16x16x32_bf16 v[64:67], a[96:99], a[64:67], v[64:67]
    s_add_u32 s66, s66, 56
    v_mov_b32 v237, 0xffff
    v_lshlrev_b32 v231, 4, v0
    v_mfma_f32_16x16x32_bf16 v[72:75], a[96:99], a[68:71], v[72:75]
    s_mul_i32 s66, s66, 130
    ds_read_b64_tr_b16 a[74:75], v9 offset:6144
    v_add_u32 v250, 4096, v231
    v_mfma_f32_16x16x32_bf16 v[20:23], a[100:103], a[40:43], v[20:23]
    s_lshl_b32 s67, s72, 3
    ds_read_b128 a[0:3], v7 offset:0
    v_cndmask_b32 v236, v236, v237, s[88:89]
    v_mfma_f32_16x16x32_bf16 v[28:31], a[100:103], a[44:47], v[28:31]
    s_add_u32 s66, s66, s67
    v_cndmask_b32 v226, 0, v236, s[90:91]
    v_cndmask_b32 v228, 0, v236, s[100:101]
    v_mfma_f32_16x16x32_bf16 v[36:39], a[100:103], a[48:51], v[36:39]
    s_lshl_b32 s66, s66, 10
    ds_read_b128 a[4:7], v7 offset:2048
    v_xor_b32 v227, v226, v236
    v_mfma_f32_16x16x32_bf16 v[44:47], a[100:103], a[52:55], v[44:47]
    s_add_u32 s85, s66, 1048576
    ds_read_b128 a[8:11], v7 offset:4096
    v_xor_b32 v229, v228, v236
    v_mfma_f32_16x16x32_bf16 v[52:55], a[100:103], a[56:59], v[52:55]
    s_mul_i32 s66, s73, 8704
    ds_read_b128 a[12:15], v7 offset:6144
    v_mov_b32 v230, 0xf149f2ca
    v_mfma_f32_16x16x32_bf16 v[60:63], a[100:103], a[60:63], v[60:63]
    s_cmp_eq_u32 s72, 0
    s_cselect_b64 s[68:69], -1, 0
    s_lshl_b32 s67, s72, 9
    v_mfma_f32_16x16x32_bf16 v[68:71], a[100:103], a[64:67], v[68:71]
    s_add_u32 s66, s66, s67
    ds_read_b128 a[16:19], v7 offset:8192
    v_lshlrev_b32 v251, 2, v0
    v_mfma_f32_16x16x32_bf16 v[76:79], a[100:103], a[68:71], v[76:79]
    s_add_u32 s66, s66, 524288
    ds_read_b128 a[20:23], v7 offset:10240
    v_min_u32 v238, 1, v0
    v_mfma_f32_16x16x32_bf16 v[80:83], a[104:107], a[36:39], v[80:83]
    s_cmp_eq_u32 s62, 0
    s_cselect_b32 s66, s66, 2147483648
    v_lshlrev_b32 v238, 31, v238
    v_mfma_f32_16x16x32_bf16 v[88:91], a[104:107], a[40:43], v[88:91]
    ds_read_b128 a[24:27], v7 offset:12288
    v_add_u32 v251, s66, v251
    v_mfma_f32_16x16x32_bf16 v[96:99], a[104:107], a[44:47], v[96:99]
    s_lshl_b32 s66, s72, 2
    ds_read_b128 a[28:31], v7 offset:14336
    v_mfma_f32_16x16x32_bf16 v[104:107], a[104:107], a[48:51], v[104:107]
    s_add_u32 s66, s66, s73
    v_mfma_f32_16x16x32_bf16 v[112:115], a[104:107], a[52:55], v[112:115]
    s_add_u32 s66, s66, 208
    ds_read_b128 a[32:35], v7 offset:16384
    v_mfma_f32_16x16x32_bf16 v[120:123], a[104:107], a[56:59], v[120:123]
    s_lshl_b32 s66, s66, 7
    ds_read_b64_tr_b16 a[76:77], v224 offset:0
    v_mfma_f32_16x16x32_bf16 v[128:131], a[104:107], a[60:63], v[128:131]
    v_or_b32 v252, s66, v238
    v_mfma_f32_16x16x32_bf16 v[136:139], a[104:107], a[64:67], v[136:139]
    ds_read_b64_tr_b16 a[78:79], v225 offset:6144
    v_mfma_f32_16x16x32_bf16 v[144:147], a[104:107], a[68:71], v[144:147]
    ds_read_b64_tr_b16 a[80:81], v9 offset:2048
    v_mfma_f32_16x16x32_bf16 v[84:87], a[108:111], a[36:39], v[84:87]
    ds_read_b64_tr_b16 a[82:83], v9 offset:8192
    v_mfma_f32_16x16x32_bf16 v[92:95], a[108:111], a[40:43], v[92:95]
    v_mfma_f32_16x16x32_bf16 v[100:103], a[108:111], a[44:47], v[100:103]
    ds_read_b64_tr_b16 a[84:85], v11 offset:2048
    v_mfma_f32_16x16x32_bf16 v[108:111], a[108:111], a[48:51], v[108:111]
    ds_read_b64_tr_b16 a[86:87], v11 offset:8192
    v_mfma_f32_16x16x32_bf16 v[116:119], a[108:111], a[52:55], v[116:119]
    v_mfma_f32_16x16x32_bf16 v[124:127], a[108:111], a[56:59], v[124:127]
    ds_read_b64_tr_b16 a[88:89], v9 offset:4096
    v_mfma_f32_16x16x32_bf16 v[132:135], a[108:111], a[60:63], v[132:135]
    ds_read_b64_tr_b16 a[90:91], v9 offset:10240
    v_mfma_f32_16x16x32_bf16 v[140:143], a[108:111], a[64:67], v[140:143]
    v_mfma_f32_16x16x32_bf16 v[148:151], a[108:111], a[68:71], v[148:151]
    ds_read_b64_tr_b16 a[92:93], v11 offset:4096
    v_mfma_f32_16x16x32_bf16 v[152:155], a[36:39], a[112:115], v[152:155]
    ds_read_b64_tr_b16 a[94:95], v11 offset:10240
    v_mfma_f32_16x16x32_bf16 v[156:159], a[40:43], a[112:115], v[156:159]
    v_mfma_f32_16x16x32_bf16 v[160:163], a[44:47], a[112:115], v[160:163]
    v_mfma_f32_16x16x32_bf16 v[164:167], a[48:51], a[112:115], v[164:167]
    v_mfma_f32_16x16x32_bf16 v[168:171], a[52:55], a[112:115], v[168:171]
    v_mfma_f32_16x16x32_bf16 v[172:175], a[56:59], a[112:115], v[172:175]
    v_mfma_f32_16x16x32_bf16 v[176:179], a[60:63], a[112:115], v[176:179]
    v_mfma_f32_16x16x32_bf16 v[180:183], a[64:67], a[112:115], v[180:183]
    v_mfma_f32_16x16x32_bf16 v[184:187], a[68:71], a[112:115], v[184:187]
    v_mfma_f32_16x16x32_bf16 v[188:191], a[36:39], a[116:119], v[188:191]
    v_mfma_f32_16x16x32_bf16 v[192:195], a[40:43], a[116:119], v[192:195]
    v_mfma_f32_16x16x32_bf16 v[196:199], a[44:47], a[116:119], v[196:199]
    v_mfma_f32_16x16x32_bf16 v[200:203], a[48:51], a[116:119], v[200:203]
    v_mfma_f32_16x16x32_bf16 v[204:207], a[52:55], a[116:119], v[204:207]
    v_mfma_f32_16x16x32_bf16 v[208:211], a[56:59], a[116:119], v[208:211]
    v_mfma_f32_16x16x32_bf16 v[212:215], a[60:63], a[116:119], v[212:215]
    v_mfma_f32_16x16x32_bf16 v[216:219], a[64:67], a[116:119], v[216:219]
    v_mfma_f32_16x16x32_bf16 v[220:223], a[68:71], a[116:119], v[220:223]
    s_waitcnt vmcnt(2) lgkmcnt(0)
    s_barrier
    v_mfma_f32_16x16x32_bf16 v[16:19], a[72:75], a[4:7], v[16:19]
    s_add_u32 s83, s3, 4294942976
    v_mfma_f32_16x16x32_bf16 v[24:27], a[72:75], a[8:11], v[24:27]
    v_mad_i32_i24 v224, v15, s83, v13
    v_mfma_f32_16x16x32_bf16 v[32:35], a[72:75], a[12:15], v[32:35]
    s_add_u32 s84, s3, 4294936864
    v_mfma_f32_16x16x32_bf16 v[40:43], a[72:75], a[16:19], v[40:43]
    v_mfma_f32_16x16x32_bf16 v[48:51], a[72:75], a[20:23], v[48:51]
    v_mad_i32_i24 v225, v15, s84, v13
    v_mfma_f32_16x16x32_bf16 v[56:59], a[72:75], a[24:27], v[56:59]
    s_add_u32 s3, s3, 512
    v_mfma_f32_16x16x32_bf16 v[64:67], a[72:75], a[28:31], v[64:67]
    s_cmp_eq_u32 s92, 6
    s_cselect_b32 s3, 0, s3
    v_mfma_f32_16x16x32_bf16 v[72:75], a[72:75], a[32:35], v[72:75]
    v_mfma_f32_16x16x32_bf16 v[20:23], a[76:79], a[4:7], v[20:23]
    ds_read_b64_tr_b16 a[96:97], v9 offset:24576
    v_mfma_f32_16x16x32_bf16 v[28:31], a[76:79], a[8:11], v[28:31]
    ds_read_b64_tr_b16 a[98:99], v9 offset:30720
    v_mfma_f32_16x16x32_bf16 v[36:39], a[76:79], a[12:15], v[36:39]
    ds_read_b128 a[36:39], v8 offset:0
    v_mfma_f32_16x16x32_bf16 v[44:47], a[76:79], a[16:19], v[44:47]
    v_mfma_f32_16x16x32_bf16 v[52:55], a[76:79], a[20:23], v[52:55]
    ds_read_b128 a[40:43], v8 offset:2048
    v_mfma_f32_16x16x32_bf16 v[60:63], a[76:79], a[24:27], v[60:63]
    ds_read_b128 a[44:47], v8 offset:4096
    v_mfma_f32_16x16x32_bf16 v[68:71], a[76:79], a[28:31], v[68:71]
    ds_read_b128 a[48:51], v8 offset:6144
    v_mfma_f32_16x16x32_bf16 v[76:79], a[76:79], a[32:35], v[76:79]
    v_mfma_f32_16x16x32_bf16 v[80:83], a[80:83], a[0:3], v[80:83]
    ds_read_b128 a[52:55], v8 offset:8192
    v_mfma_f32_16x16x32_bf16 v[88:91], a[80:83], a[4:7], v[88:91]
    ds_read_b128 a[56:59], v8 offset:10240
    v_mfma_f32_16x16x32_bf16 v[96:99], a[80:83], a[8:11], v[96:99]
    ds_read_b128 a[60:63], v8 offset:12288
    v_mfma_f32_16x16x32_bf16 v[104:107], a[80:83], a[12:15], v[104:107]
    v_mfma_f32_16x16x32_bf16 v[112:115], a[80:83], a[16:19], v[112:115]
    ds_read_b128 a[64:67], v8 offset:14336
    v_mfma_f32_16x16x32_bf16 v[120:123], a[80:83], a[20:23], v[120:123]
    ds_read_b128 a[68:71], v8 offset:16384
    v_mfma_f32_16x16x32_bf16 v[128:131], a[80:83], a[24:27], v[128:131]
    ds_read_b64_tr_b16 a[100:101], v224 offset:24576
    v_mfma_f32_16x16x32_bf16 v[136:139], a[80:83], a[28:31], v[136:139]
    v_mfma_f32_16x16x32_bf16 v[144:147], a[80:83], a[32:35], v[144:147]
    ds_read_b64_tr_b16 a[102:103], v225 offset:30720
    v_mfma_f32_16x16x32_bf16 v[84:87], a[84:87], a[0:3], v[84:87]
    ds_read_b64_tr_b16 a[104:105], v9 offset:26624
    v_mfma_f32_16x16x32_bf16 v[92:95], a[84:87], a[4:7], v[92:95]
    ds_read_b64_tr_b16 a[106:107], v9 offset:32768
    v_mfma_f32_16x16x32_bf16 v[100:103], a[84:87], a[8:11], v[100:103]
    v_mfma_f32_16x16x32_bf16 v[108:111], a[84:87], a[12:15], v[108:111]
    ds_read_b64_tr_b16 a[108:109], v11 offset:26624
    v_mfma_f32_16x16x32_bf16 v[116:119], a[84:87], a[16:19], v[116:119]
    ds_read_b64_tr_b16 a[110:111], v11 offset:32768
    v_mfma_f32_16x16x32_bf16 v[124:127], a[84:87], a[20:23], v[124:127]
    ds_read_b64_tr_b16 a[112:113], v9 offset:28672
    v_mfma_f32_16x16x32_bf16 v[132:135], a[84:87], a[24:27], v[132:135]
    v_mfma_f32_16x16x32_bf16 v[140:143], a[84:87], a[28:31], v[140:143]
    ds_read_b64_tr_b16 a[114:115], v9 offset:34816
    v_mfma_f32_16x16x32_bf16 v[148:151], a[84:87], a[32:35], v[148:151]
    ds_read_b64_tr_b16 a[116:117], v11 offset:28672
    v_mfma_f32_16x16x32_bf16 v[152:155], a[0:3], a[88:91], v[152:155]
    ds_read_b64_tr_b16 a[118:119], v11 offset:34816
    v_mfma_f32_16x16x32_bf16 v[156:159], a[4:7], a[88:91], v[156:159]
    v_mfma_f32_16x16x32_bf16 v[160:163], a[8:11], a[88:91], v[160:163]
    v_mfma_f32_16x16x32_bf16 v[164:167], a[12:15], a[88:91], v[164:167]
    v_mfma_f32_16x16x32_bf16 v[168:171], a[16:19], a[88:91], v[168:171]
    v_mfma_f32_16x16x32_bf16 v[172:175], a[20:23], a[88:91], v[172:175]
    v_mfma_f32_16x16x32_bf16 v[176:179], a[24:27], a[88:91], v[176:179]
    v_mfma_f32_16x16x32_bf16 v[180:183], a[28:31], a[88:91], v[180:183]
    v_mfma_f32_16x16x32_bf16 v[184:187], a[32:35], a[88:91], v[184:187]
    v_mfma_f32_16x16x32_bf16 v[188:191], a[0:3], a[92:95], v[188:191]
    v_mfma_f32_16x16x32_bf16 v[192:195], a[4:7], a[92:95], v[192:195]
    v_mfma_f32_16x16x32_bf16 v[196:199], a[8:11], a[92:95], v[196:199]
    v_mfma_f32_16x16x32_bf16 v[200:203], a[12:15], a[92:95], v[200:203]
    v_mfma_f32_16x16x32_bf16 v[204:207], a[16:19], a[92:95], v[204:207]
    v_mfma_f32_16x16x32_bf16 v[208:211], a[20:23], a[92:95], v[208:211]
    v_mfma_f32_16x16x32_bf16 v[212:215], a[24:27], a[92:95], v[212:215]
    v_mfma_f32_16x16x32_bf16 v[216:219], a[28:31], a[92:95], v[216:219]
    v_mfma_f32_16x16x32_bf16 v[220:223], a[32:35], a[92:95], v[220:223]
    s_waitcnt lgkmcnt(0)
    s_barrier
    v_mfma_f32_16x16x32_bf16 v[16:19], a[96:99], a[40:43], v[16:19]
    v_mfma_f32_16x16x32_bf16 v[20:23], a[100:103], a[40:43], v[20:23]
    v_mfma_f32_16x16x32_bf16 v[24:27], a[96:99], a[44:47], v[24:27]
    v_mfma_f32_16x16x32_bf16 v[28:31], a[100:103], a[44:47], v[28:31]
    v_mfma_f32_16x16x32_bf16 v[32:35], a[96:99], a[48:51], v[32:35]
    v_mfma_f32_16x16x32_bf16 v[36:39], a[100:103], a[48:51], v[36:39]
    s_nop 2
    v_cvt_pk_bf16_f32 v16, v16, v17
    v_cvt_pk_bf16_f32 v17, v18, v19
    v_mfma_f32_16x16x32_bf16 v[40:43], a[96:99], a[52:55], v[40:43]
    v_cvt_pk_bf16_f32 v18, v20, v21
    v_cvt_pk_bf16_f32 v19, v22, v23
    v_mfma_f32_16x16x32_bf16 v[44:47], a[100:103], a[52:55], v[44:47]
    v_cvt_pk_bf16_f32 v24, v24, v25
    v_cvt_pk_bf16_f32 v25, v26, v27
    v_mfma_f32_16x16x32_bf16 v[48:51], a[96:99], a[56:59], v[48:51]
    v_cvt_pk_bf16_f32 v26, v28, v29
    v_cvt_pk_bf16_f32 v27, v30, v31
    v_mfma_f32_16x16x32_bf16 v[52:55], a[100:103], a[56:59], v[52:55]
    v_cvt_pk_bf16_f32 v32, v32, v33
    v_cvt_pk_bf16_f32 v33, v34, v35
    v_mfma_f32_16x16x32_bf16 v[56:59], a[96:99], a[60:63], v[56:59]
    v_cvt_pk_bf16_f32 v34, v36, v37
    v_cvt_pk_bf16_f32 v35, v38, v39
    v_mfma_f32_16x16x32_bf16 v[60:63], a[100:103], a[60:63], v[60:63]
    v_cvt_pk_bf16_f32 v40, v40, v41
    v_cvt_pk_bf16_f32 v41, v42, v43
    v_mfma_f32_16x16x32_bf16 v[64:67], a[96:99], a[64:67], v[64:67]
    v_cvt_pk_bf16_f32 v42, v44, v45
    v_cvt_pk_bf16_f32 v43, v46, v47
    v_mfma_f32_16x16x32_bf16 v[68:71], a[100:103], a[64:67], v[68:71]
    v_cvt_pk_bf16_f32 v48, v48, v49
    v_cvt_pk_bf16_f32 v49, v50, v51
    v_mfma_f32_16x16x32_bf16 v[72:75], a[96:99], a[68:71], v[72:75]
    v_cvt_pk_bf16_f32 v50, v52, v53
    v_cvt_pk_bf16_f32 v51, v54, v55
    v_mfma_f32_16x16x32_bf16 v[76:79], a[100:103], a[68:71], v[76:79]
    v_cvt_pk_bf16_f32 v56, v56, v57
    v_cvt_pk_bf16_f32 v57, v58, v59
    v_mfma_f32_16x16x32_bf16 v[80:83], a[104:107], a[36:39], v[80:83]
    v_cvt_pk_bf16_f32 v58, v60, v61
    v_cvt_pk_bf16_f32 v59, v62, v63
    v_mfma_f32_16x16x32_bf16 v[84:87], a[108:111], a[36:39], v[84:87]
    v_cvt_pk_bf16_f32 v64, v64, v65
    v_cvt_pk_bf16_f32 v65, v66, v67
    v_mfma_f32_16x16x32_bf16 v[88:91], a[104:107], a[40:43], v[88:91]
    v_cvt_pk_bf16_f32 v66, v68, v69
    v_cvt_pk_bf16_f32 v67, v70, v71
    v_mfma_f32_16x16x32_bf16 v[92:95], a[108:111], a[40:43], v[92:95]
    v_cvt_pk_bf16_f32 v72, v72, v73
    v_cvt_pk_bf16_f32 v73, v74, v75
    v_mfma_f32_16x16x32_bf16 v[96:99], a[104:107], a[44:47], v[96:99]
    v_cvt_pk_bf16_f32 v74, v76, v77
    v_cvt_pk_bf16_f32 v75, v78, v79
    v_mfma_f32_16x16x32_bf16 v[100:103], a[108:111], a[44:47], v[100:103]
    v_cvt_pk_bf16_f32 v80, v80, v81
    v_cvt_pk_bf16_f32 v81, v82, v83
    v_mfma_f32_16x16x32_bf16 v[104:107], a[104:107], a[48:51], v[104:107]
    v_cvt_pk_bf16_f32 v82, v84, v85
    v_cvt_pk_bf16_f32 v83, v86, v87
    v_mfma_f32_16x16x32_bf16 v[108:111], a[108:111], a[48:51], v[108:111]
    v_cvt_pk_bf16_f32 v88, v88, v89
    v_cvt_pk_bf16_f32 v89, v90, v91
    v_mfma_f32_16x16x32_bf16 v[112:115], a[104:107], a[52:55], v[112:115]
    v_cvt_pk_bf16_f32 v90, v92, v93
    v_cvt_pk_bf16_f32 v91, v94, v95
    v_mfma_f32_16x16x32_bf16 v[116:119], a[108:111], a[52:55], v[116:119]
    v_permlane16_swap_b32 v36, v44
    v_permlane16_swap_b32 v68, v76
    v_mfma_f32_16x16x32_bf16 v[120:123], a[104:107], a[56:59], v[120:123]
    v_cvt_pk_bf16_f32 v96, v96, v97
    v_cvt_pk_bf16_f32 v97, v98, v99
    v_mfma_f32_16x16x32_bf16 v[124:127], a[108:111], a[56:59], v[124:127]
    v_cvt_pk_bf16_f32 v98, v100, v101
    v_cvt_pk_bf16_f32 v99, v102, v103
    v_mfma_f32_16x16x32_bf16 v[128:131], a[104:107], a[60:63], v[128:131]
    v_cvt_pk_bf16_f32 v104, v104, v105
    v_cvt_pk_bf16_f32 v105, v106, v107
    v_mfma_f32_16x16x32_bf16 v[132:135], a[108:111], a[60:63], v[132:135]
    v_cvt_pk_bf16_f32 v106, v108, v109
    v_cvt_pk_bf16_f32 v107, v110, v111
    v_mfma_f32_16x16x32_bf16 v[136:139], a[104:107], a[64:67], v[136:139]
    v_permlane16_swap_b32 v20, v28
    v_permlane16_swap_b32 v52, v60
    v_mfma_f32_16x16x32_bf16 v[140:143], a[108:111], a[64:67], v[140:143]
    v_cvt_pk_bf16_f32 v112, v112, v113
    v_cvt_pk_bf16_f32 v113, v114, v115
    v_mfma_f32_16x16x32_bf16 v[144:147], a[104:107], a[68:71], v[144:147]
    v_cvt_pk_bf16_f32 v114, v116, v117
    v_cvt_pk_bf16_f32 v115, v118, v119
    v_mfma_f32_16x16x32_bf16 v[148:151], a[108:111], a[68:71], v[148:151]
    v_cvt_pk_bf16_f32 v120, v120, v121
    v_cvt_pk_bf16_f32 v121, v122, v123
    v_mfma_f32_16x16x32_bf16 v[152:155], a[36:39], a[112:115], v[152:155]
    v_cvt_pk_bf16_f32 v122, v124, v125
    v_cvt_pk_bf16_f32 v123, v126, v127
    v_mfma_f32_16x16x32_bf16 v[156:159], a[40:43], a[112:115], v[156:159]
    v_permlane32_swap_b32 v28, v44
    v_permlane32_swap_b32 v60, v76
    v_mfma_f32_16x16x32_bf16 v[160:163], a[44:47], a[112:115], v[160:163]
    v_cvt_pk_bf16_f32 v128, v128, v129
    v_cvt_pk_bf16_f32 v129, v130, v131
    v_mfma_f32_16x16x32_bf16 v[164:167], a[48:51], a[112:115], v[164:167]
    v_cvt_pk_bf16_f32 v130, v132, v133
    v_cvt_pk_bf16_f32 v131, v134, v135
    v_mfma_f32_16x16x32_bf16 v[168:171], a[52:55], a[112:115], v[168:171]
    v_cvt_pk_bf16_f32 v136, v136, v137
    v_cvt_pk_bf16_f32 v137, v138, v139
    v_mfma_f32_16x16x32_bf16 v[172:175], a[56:59], a[112:115], v[172:175]
    v_cvt_pk_bf16_f32 v138, v140, v141
    v_cvt_pk_bf16_f32 v139, v142, v143
    v_mfma_f32_16x16x32_bf16 v[176:179], a[60:63], a[112:115], v[176:179]
    v_cvt_pk_bf16_f32 v144, v144, v145
    v_cvt_pk_bf16_f32 v145, v146, v147
    v_mfma_f32_16x16x32_bf16 v[180:183], a[64:67], a[112:115], v[180:183]
    v_cvt_pk_bf16_f32 v146, v148, v149
    v_cvt_pk_bf16_f32 v147, v150, v151
    v_mfma_f32_16x16x32_bf16 v[184:187], a[68:71], a[112:115], v[184:187]
    v_mul_f32 v224, s82, v44
    v_mul_f32 v225, s82, v76
    v_mfma_f32_16x16x32_bf16 v[188:191], a[36:39], a[116:119], v[188:191]
    v_cvt_pk_bf16_f32 v152, v152, v153
    v_cvt_pk_bf16_f32 v153, v154, v155
    v_mfma_f32_16x16x32_bf16 v[192:195], a[40:43], a[116:119], v[192:195]
    v_cvt_pk_bf16_f32 v154, v156, v157
    v_cvt_pk_bf16_f32 v155, v158, v159
    v_mfma_f32_16x16x32_bf16 v[196:199], a[44:47], a[116:119], v[196:199]
    v_cvt_pk_bf16_f32 v156, v160, v161
    v_cvt_pk_bf16_f32 v157, v162, v163
    v_mfma_f32_16x16x32_bf16 v[200:203], a[48:51], a[116:119], v[200:203]
    v_min_f32 v224, 0x42c80000, v224
    v_min_f32 v225, 0x42c80000, v225
    v_mfma_f32_16x16x32_bf16 v[204:207], a[52:55], a[116:119], v[204:207]
    v_cvt_pk_bf16_f32 v158, v164, v165
    v_cvt_pk_bf16_f32 v159, v166, v167
    v_mfma_f32_16x16x32_bf16 v[208:211], a[56:59], a[116:119], v[208:211]
    v_cvt_pk_bf16_f32 v160, v168, v169
    v_cvt_pk_bf16_f32 v161, v170, v171
    v_mfma_f32_16x16x32_bf16 v[212:215], a[60:63], a[116:119], v[212:215]
    v_exp_f32 v224, v224
    v_mfma_f32_16x16x32_bf16 v[216:219], a[64:67], a[116:119], v[216:219]
    v_exp_f32 v225, v225
    v_mfma_f32_16x16x32_bf16 v[220:223], a[68:71], a[116:119], v[220:223]
    v_cvt_pk_bf16_f32 v162, v172, v173
    v_cvt_pk_bf16_f32 v163, v174, v175
    v_mfma_f32_16x16x32_bf16 v[84:87], v[80:83], v[16:19], 0
    v_cvt_pk_bf16_f32 v164, v176, v177
    v_cvt_pk_bf16_f32 v165, v178, v179
    v_mfma_f32_16x16x32_bf16 v[20:23], v[88:91], v[16:19], 0
    v_add_f32 v7, 1.0, v224
    v_add_f32 v8, 1.0, v225
    v_mfma_f32_16x16x32_bf16 v[92:95], v[88:91], v[24:27], 0
    v_cvt_pk_bf16_f32 v166, v180, v181
    v_cvt_pk_bf16_f32 v167, v182, v183
    v_mfma_f32_16x16x32_bf16 v[28:31], v[96:99], v[24:27], 0
    v_cvt_pk_bf16_f32 v168, v184, v185
    v_cvt_pk_bf16_f32 v169, v186, v187
    v_mfma_f32_16x16x32_bf16 v[100:103], v[96:99], v[32:35], 0
    v_cvt_pk_bf16_f32 v188, v188, v189
    v_cvt_pk_bf16_f32 v189, v190, v191
    v_mfma_f32_16x16x32_bf16 v[36:39], v[104:107], v[32:35], 0
    v_cvt_pk_bf16_f32 v190, v192, v193
    v_cvt_pk_bf16_f32 v191, v194, v195
    v_mfma_f32_16x16x32_bf16 v[108:111], v[104:107], v[40:43], 0
    v_cvt_pk_bf16_f32 v192, v196, v197
    v_cvt_pk_bf16_f32 v193, v198, v199
    v_mfma_f32_16x16x32_bf16 v[44:47], v[112:115], v[40:43], 0
    v_cvt_pk_bf16_f32 v194, v200, v201
    v_cvt_pk_bf16_f32 v195, v202, v203
    v_mfma_f32_16x16x32_bf16 v[116:119], v[112:115], v[48:51], 0
    v_cvt_pk_bf16_f32 v196, v204, v205
    v_cvt_pk_bf16_f32 v197, v206, v207
    v_mfma_f32_16x16x32_bf16 v[52:55], v[120:123], v[48:51], 0
    v_cvt_pk_bf16_f32 v198, v208, v209
    v_cvt_pk_bf16_f32 v199, v210, v211
    v_mfma_f32_16x16x32_bf16 v[124:127], v[120:123], v[56:59], 0
    v_cvt_pk_bf16_f32 v200, v212, v213
    v_cvt_pk_bf16_f32 v201, v214, v215
    v_mfma_f32_16x16x32_bf16 v[60:63], v[128:131], v[56:59], 0
    v_cvt_pk_bf16_f32 v202, v216, v217
    v_cvt_pk_bf16_f32 v203, v218, v219
    v_mfma_f32_16x16x32_bf16 v[132:135], v[128:131], v[64:67], 0
    v_cvt_pk_bf16_f32 v204, v220, v221
    v_cvt_pk_bf16_f32 v205, v222, v223
    v_mfma_f32_16x16x32_bf16 v[68:71], v[136:139], v[64:67], 0
    v_mfma_f32_16x16x32_bf16 v[140:143], v[136:139], v[72:75], 0
    v_mfma_f32_16x16x32_bf16 v[76:79], v[144:147], v[72:75], 0
    v_cndmask_b32 v170, v85, v84, s[88:89]
    v_cndmask_b32 v178, v87, v86, s[88:89]
    v_cndmask_b32 v232, v21, v20, s[88:89]
    v_cndmask_b32 v240, v23, v22, s[88:89]
    v_cndmask_b32 v170, v170, v230, s[68:69]
    v_cndmask_b32 v178, v178, v230, s[68:69]
    v_cndmask_b32 v232, v170, v232, s[90:91]
    v_cndmask_b32 v240, v178, v240, s[100:101]
    v_max_f32 v170, v232, v240
    v_cndmask_b32 v171, v93, v92, s[88:89]
    v_cndmask_b32 v179, v95, v94, s[88:89]
    v_cndmask_b32 v233, v29, v28, s[88:89]
    v_cndmask_b32 v241, v31, v30, s[88:89]
    v_cndmask_b32 v233, v171, v233, s[90:91]
    v_cndmask_b32 v241, v179, v241, s[100:101]
    v_max_f32 v171, v233, v241
    v_cndmask_b32 v172, v101, v100, s[88:89]
    v_cndmask_b32 v180, v103, v102, s[88:89]
    v_cndmask_b32 v234, v37, v36, s[88:89]
    v_cndmask_b32 v242, v39, v38, s[88:89]
    v_cndmask_b32 v234, v172, v234, s[90:91]
    v_cndmask_b32 v242, v180, v242, s[100:101]
    v_max_f32 v172, v234, v242
    v_cndmask_b32 v173, v109, v108, s[88:89]
    v_cndmask_b32 v181, v111, v110, s[88:89]
    v_cndmask_b32 v235, v45, v44, s[88:89]
    v_cndmask_b32 v243, v47, v46, s[88:89]
    v_cndmask_b32 v235, v173, v235, s[90:91]
    v_cndmask_b32 v243, v181, v243, s[100:101]
    v_max_f32 v173, v235, v243
    v_cndmask_b32 v174, v117, v116, s[88:89]
    v_cndmask_b32 v182, v119, v118, s[88:89]
    v_cndmask_b32 v236, v53, v52, s[88:89]
    v_cndmask_b32 v244, v55, v54, s[88:89]
    v_cndmask_b32 v236, v174, v236, s[90:91]
    v_cndmask_b32 v244, v182, v244, s[100:101]
    v_max_f32 v174, v236, v244
    v_cndmask_b32 v175, v125, v124, s[88:89]
    v_cndmask_b32 v183, v127, v126, s[88:89]
    v_cndmask_b32 v237, v61, v60, s[88:89]
    v_cndmask_b32 v245, v63, v62, s[88:89]
    v_cndmask_b32 v237, v175, v237, s[90:91]
    v_cndmask_b32 v245, v183, v245, s[100:101]
    v_max_f32 v175, v237, v245
    v_cndmask_b32 v176, v133, v132, s[88:89]
    v_cndmask_b32 v184, v135, v134, s[88:89]
    v_cndmask_b32 v238, v69, v68, s[88:89]
    v_cndmask_b32 v246, v71, v70, s[88:89]
    v_cndmask_b32 v238, v176, v238, s[90:91]
    v_cndmask_b32 v246, v184, v246, s[100:101]
    v_max_f32 v176, v238, v246
    v_cndmask_b32 v177, v141, v140, s[88:89]
    v_cndmask_b32 v185, v143, v142, s[88:89]
    v_cndmask_b32 v239, v77, v76, s[88:89]
    v_cndmask_b32 v247, v79, v78, s[88:89]
    v_cndmask_b32 v239, v177, v239, s[90:91]
    v_cndmask_b32 v247, v185, v247, s[100:101]
    v_max_f32 v177, v239, v247
    v_permlane32_swap_b32 v170, v172
    v_permlane32_swap_b32 v171, v173
    v_permlane32_swap_b32 v174, v176
    v_permlane32_swap_b32 v175, v177
    v_max_f32 v170, v170, v172
    v_max_f32 v171, v171, v173
    v_max_f32 v174, v174, v176
    v_max_f32 v175, v175, v177
    v_permlane16_swap_b32 v170, v171
    s_nop 0
    v_permlane16_swap_b32 v174, v175
    v_max_f32 v170, v170, v171
    v_max_f32 v174, v174, v175
    v_mul_f32 v170, s86, v170
    v_mul_f32 v174, s86, v174
    v_mov_b32 v171, v170
    v_mov_b32 v175, v174
    s_nop 0
    v_permlane16_swap_b32 v170, v171
    v_permlane16_swap_b32 v174, v175
    v_mov_b32 v172, v170
    v_mov_b32 v173, v171
    v_mov_b32 v176, v174
    v_mov_b32 v177, v175
    v_permlane32_swap_b32 v170, v172
    v_permlane32_swap_b32 v171, v173
    v_permlane32_swap_b32 v174, v176
    v_permlane32_swap_b32 v175, v177
    v_fma_f32 v232, v232, s86, -v170
    v_fma_f32 v240, v240, s86, -v170
    v_fma_f32 v233, v233, s86, -v171
    v_fma_f32 v241, v241, s86, -v171
    v_fma_f32 v234, v234, s86, -v172
    v_fma_f32 v242, v242, s86, -v172
    v_fma_f32 v235, v235, s86, -v173
    v_fma_f32 v243, v243, s86, -v173
    v_fma_f32 v236, v236, s86, -v174
    v_fma_f32 v244, v244, s86, -v174
    v_fma_f32 v237, v237, s86, -v175
    v_fma_f32 v245, v245, s86, -v175
    v_fma_f32 v238, v238, s86, -v176
    v_fma_f32 v246, v246, s86, -v176
    v_fma_f32 v239, v239, s86, -v177
    v_fma_f32 v247, v247, s86, -v177
    v_exp_f32 v232, v232
    v_exp_f32 v240, v240
    v_exp_f32 v233, v233
    v_exp_f32 v241, v241
    v_add_f32 v206, v232, v240
    v_exp_f32 v234, v234
    v_exp_f32 v242, v242
    v_add_f32 v207, v233, v241
    v_exp_f32 v235, v235
    v_exp_f32 v243, v243
    v_add_f32 v208, v234, v242
    v_exp_f32 v236, v236
    v_exp_f32 v244, v244
    v_add_f32 v209, v235, v243
    v_exp_f32 v237, v237
    v_exp_f32 v245, v245
    v_add_f32 v210, v236, v244
    v_exp_f32 v238, v238
    v_exp_f32 v246, v246
    v_add_f32 v211, v237, v245
    v_exp_f32 v239, v239
    v_exp_f32 v247, v247
    v_add_f32 v212, v238, v246
    v_add_f32 v213, v239, v247
    v_permlane32_swap_b32 v206, v208
    v_permlane32_swap_b32 v207, v209
    v_permlane32_swap_b32 v210, v212
    v_permlane32_swap_b32 v211, v213
    v_add_f32 v206, v206, v208
    v_add_f32 v207, v207, v209
    v_add_f32 v210, v210, v212
    v_add_f32 v211, v211, v213
    v_permlane16_swap_b32 v206, v207
    s_nop 0
    v_permlane16_swap_b32 v210, v211
    v_add_f32 v206, v206, v207
    v_add_f32 v210, v210, v211
    v_rcp_f32 v206, v206
    v_rcp_f32 v210, v210
    v_rcp_f32 v178, v7
    v_rcp_f32 v182, v8
    v_mul_f32 v206, v206, v224
    v_mul_f32 v210, v210, v225
    buffer_store_dword v178, v251, s[24:27], 0 offen sc1
    buffer_store_dword v182, v251, s[24:27], 0 offen offset:256 sc1
    v_mov_b32 v207, v206
    v_mov_b32 v211, v210
    s_nop 0
    v_permlane16_swap_b32 v206, v207
    v_permlane16_swap_b32 v210, v211
    v_mov_b32 v208, v206
    v_mov_b32 v209, v207
    v_mov_b32 v212, v210
    v_mov_b32 v213, v211
    v_permlane32_swap_b32 v206, v208
    v_permlane32_swap_b32 v207, v209
    v_permlane32_swap_b32 v210, v212
    v_permlane32_swap_b32 v211, v213
    v_mul_f32 v232, v232, v206
    v_mul_f32 v240, v240, v206
    v_cvt_pk_bf16_f32 v232, v232, v232
    v_cvt_pk_bf16_f32 v240, v240, v240
    v_and_b32 v16, v227, v232
    v_and_b32 v17, v229, v240
    v_and_b32 v18, v226, v232
    v_and_b32 v19, v228, v240
    v_mul_f32 v233, v233, v207
    v_mul_f32 v241, v241, v207
    v_mfma_f32_16x16x32_bf16 v[84:87], v[152:155], v[16:19], 0
    v_cvt_pk_bf16_f32 v233, v233, v233
    v_cvt_pk_bf16_f32 v241, v241, v241
    v_mfma_f32_16x16x32_bf16 v[20:23], v[188:191], v[16:19], 0
    v_and_b32 v24, v227, v233
    v_and_b32 v25, v229, v241
    v_and_b32 v26, v226, v233
    v_and_b32 v27, v228, v241
    v_mov_b32 v13, 1
    v_mul_f32 v234, v234, v208
    v_mul_f32 v242, v242, v208
    v_mfma_f32_16x16x32_bf16 v[92:95], v[154:157], v[24:27], 0
    v_cvt_pk_bf16_f32 v234, v234, v234
    v_cvt_pk_bf16_f32 v242, v242, v242
    v_mfma_f32_16x16x32_bf16 v[28:31], v[190:193], v[24:27], 0
    v_and_b32 v32, v227, v234
    v_and_b32 v33, v229, v242
    v_and_b32 v34, v226, v234
    v_and_b32 v35, v228, v242
    v_mul_f32 v235, v235, v209
    v_mul_f32 v243, v243, v209
    v_mfma_f32_16x16x32_bf16 v[100:103], v[156:159], v[32:35], 0
    v_cvt_pk_bf16_f32 v235, v235, v235
    v_cvt_pk_bf16_f32 v243, v243, v243
    v_mfma_f32_16x16x32_bf16 v[36:39], v[192:195], v[32:35], 0
    v_and_b32 v40, v227, v235
    v_and_b32 v41, v229, v243
    v_and_b32 v42, v226, v235
    v_and_b32 v43, v228, v243
    v_cvt_pk_bf16_f32 v16, v84, v85
    v_cvt_pk_bf16_f32 v17, v86, v87
    v_cvt_pk_bf16_f32 v18, v20, v21
    v_cvt_pk_bf16_f32 v19, v22, v23
    buffer_store_dwordx4 v[16:19], v231, s[24:27], s85 offen offset:0 sc1
    v_mul_f32 v236, v236, v210
    v_mul_f32 v244, v244, v210
    v_mfma_f32_16x16x32_bf16 v[108:111], v[158:161], v[40:43], 0
    v_cvt_pk_bf16_f32 v236, v236, v236
    v_cvt_pk_bf16_f32 v244, v244, v244
    v_mfma_f32_16x16x32_bf16 v[44:47], v[194:197], v[40:43], 0
    v_and_b32 v48, v227, v236
    v_and_b32 v49, v229, v244
    v_and_b32 v50, v226, v236
    v_and_b32 v51, v228, v244
    v_cvt_pk_bf16_f32 v24, v92, v93
    v_cvt_pk_bf16_f32 v25, v94, v95
    v_cvt_pk_bf16_f32 v26, v28, v29
    v_cvt_pk_bf16_f32 v27, v30, v31
    buffer_store_dwordx4 v[24:27], v231, s[24:27], s85 offen offset:1024 sc1
    v_mul_f32 v237, v237, v211
    v_mul_f32 v245, v245, v211
    v_mfma_f32_16x16x32_bf16 v[116:119], v[160:163], v[48:51], 0
    v_cvt_pk_bf16_f32 v237, v237, v237
    v_cvt_pk_bf16_f32 v245, v245, v245
    v_mfma_f32_16x16x32_bf16 v[52:55], v[196:199], v[48:51], 0
    v_and_b32 v56, v227, v237
    v_and_b32 v57, v229, v245
    v_and_b32 v58, v226, v237
    v_and_b32 v59, v228, v245
    v_cvt_pk_bf16_f32 v32, v100, v101
    v_cvt_pk_bf16_f32 v33, v102, v103
    v_cvt_pk_bf16_f32 v34, v36, v37
    v_cvt_pk_bf16_f32 v35, v38, v39
    buffer_store_dwordx4 v[32:35], v231, s[24:27], s85 offen offset:2048 sc1
    v_mul_f32 v238, v238, v212
    v_mul_f32 v246, v246, v212
    v_mfma_f32_16x16x32_bf16 v[124:127], v[162:165], v[56:59], 0
    v_cvt_pk_bf16_f32 v238, v238, v238
    v_cvt_pk_bf16_f32 v246, v246, v246
    v_mfma_f32_16x16x32_bf16 v[60:63], v[198:201], v[56:59], 0
    v_and_b32 v64, v227, v238
    v_and_b32 v65, v229, v246
    v_and_b32 v66, v226, v238
    v_and_b32 v67, v228, v246
    v_cvt_pk_bf16_f32 v40, v108, v109
    v_cvt_pk_bf16_f32 v41, v110, v111
    v_cvt_pk_bf16_f32 v42, v44, v45
    v_cvt_pk_bf16_f32 v43, v46, v47
    buffer_store_dwordx4 v[40:43], v231, s[24:27], s85 offen offset:3072 sc1
    v_mul_f32 v239, v239, v213
    v_mul_f32 v247, v247, v213
    v_mfma_f32_16x16x32_bf16 v[132:135], v[164:167], v[64:67], 0
    v_cvt_pk_bf16_f32 v239, v239, v239
    v_cvt_pk_bf16_f32 v247, v247, v247
    v_mfma_f32_16x16x32_bf16 v[68:71], v[200:203], v[64:67], 0
    v_and_b32 v72, v227, v239
    v_and_b32 v73, v229, v247
    v_and_b32 v74, v226, v239
    v_and_b32 v75, v228, v247
    v_cvt_pk_bf16_f32 v48, v116, v117
    v_cvt_pk_bf16_f32 v49, v118, v119
    v_cvt_pk_bf16_f32 v50, v52, v53
    v_cvt_pk_bf16_f32 v51, v54, v55
    buffer_store_dwordx4 v[48:51], v250, s[24:27], s85 offen offset:0 sc1
    v_mfma_f32_16x16x32_bf16 v[140:143], v[166:169], v[72:75], 0
    v_mfma_f32_16x16x32_bf16 v[76:79], v[202:205], v[72:75], 0
    v_cvt_pk_bf16_f32 v56, v124, v125
    v_cvt_pk_bf16_f32 v57, v126, v127
    v_cvt_pk_bf16_f32 v58, v60, v61
    v_cvt_pk_bf16_f32 v59, v62, v63
    buffer_store_dwordx4 v[56:59], v250, s[24:27], s85 offen offset:1024 sc1
    v_cvt_pk_bf16_f32 v64, v132, v133
    v_cvt_pk_bf16_f32 v65, v134, v135
    v_cvt_pk_bf16_f32 v66, v68, v69
    v_cvt_pk_bf16_f32 v67, v70, v71
    buffer_store_dwordx4 v[64:67], v250, s[24:27], s85 offen offset:2048 sc1
    v_cvt_pk_bf16_f32 v72, v140, v141
    v_cvt_pk_bf16_f32 v73, v142, v143
    v_cvt_pk_bf16_f32 v74, v76, v77
    v_cvt_pk_bf16_f32 v75, v78, v79
    buffer_store_dwordx4 v[72:75], v250, s[24:27], s85 offen offset:3072 sc1
    v_cmp_ne_u32 vcc, 1, v248
    s_nop 1
    s_cbranch_vccz CK13
    s_mov_b32 s92, 0
SP14:
    buffer_load_dword v248, v249, s[32:35], 0 offen offset:0 sc1
    s_waitcnt vmcnt(0)
    v_cmp_ne_u32 vcc, 1, v248
    s_nop 1
    s_cbranch_vccz SD15
    s_add_u32 s92, s92, 1
    s_cmp_lt_u32 s92, 0x40000
    s_sleep 1
    s_cbranch_scc1 SP14
SD15:
CK13:
    s_waitcnt vmcnt(0) lgkmcnt(0)
    buffer_atomic_add v13, v252, s[24:27], 0 offen
    s_mul_i32 s66, s63, 23
    s_lshr_b32 s67, s63, 2
    s_sub_u32 s66, s66, s67
    s_add_u32 s67, s66, 22
    s_mul_i32 s66, s66, 9363
    s_lshr_b32 s40, s66, 16
    s_mul_i32 s67, s67, 9363
    s_lshr_b32 s41, s67, 16
    s_min_u32 s41, s41, 25
    s_sub_u32 s42, s64, 1
    s_lshl_b32 s42, s42, 2
    s_add_u32 s42, s42, s62
    s_sub_u32 s43, s41, s40
    s_add_u32 s43, s43, 1
    s_mul_i32 s43, s43, 40
    s_sub_u32 s43, s43, 1
    s_mul_i32 s44, s40, 5
    s_cmp_ge_u32 s42, 28
    s_cbranch_scc1 NB16
    s_lshr_b32 s45, s42, 1
    s_and_b32 s46, s42, 1
    s_cmp_ge_u32 s45, 7
    s_cselect_b32 s47, 2, 0
    s_add_u32 s47, s47, s46
    v_min_u32 v22, 4, v0
    v_add_u32 v22, s40, v22
    v_min_u32 v22, s41, v22
    v_lshlrev_b32 v22, 3, v22
    v_add_u32 v22, s47, v22
    v_lshlrev_b32 v22, 7, v22
    s_mov_b32 s92, 0
SP17:
    buffer_load_dword v23, v22, s[24:27], 0 offen offset:512 sc1
    s_waitcnt vmcnt(0)
    v_cmp_ne_u32 vcc, 7, v23
    s_nop 1
    s_cbranch_vccz SD18
    s_add_u32 s92, s92, 1
    s_cmp_lt_u32 s92, 0x40000
    s_sleep 8
    s_cbranch_scc1 SP17
SD18:
    s_lshl_b32 s45, s45, 2
    s_add_u32 s45, s45, s46
    s_add_u32 s45, s45, 2
    s_mul_i32 s66, s45, 130
    s_add_u32 s66, s66, s44
    s_lshl_b32 s66, s66, 10
    s_add_u32 s66, s66, 1048576
    v_add_u32 v20, 0, v0
    v_min_u32 v21, s43, v20
    v_lshlrev_b32 v21, 7, v21
    buffer_load_dword v24, v21, s[24:27], s66 offen sc1
    v_add_u32 v20, 64, v20
    v_min_u32 v21, s43, v20
    v_lshlrev_b32 v21, 7, v21
    buffer_load_dword v25, v21, s[24:27], s66 offen sc1
    v_add_u32 v20, 64, v20
    v_min_u32 v21, s43, v20
    v_lshlrev_b32 v21, 7, v21
    buffer_load_dword v26, v21, s[24:27], s66 offen sc1
    v_add_u32 v20, 64, v20
    v_min_u32 v21, s43, v20
    v_lshlrev_b32 v21, 7, v21
    buffer_load_dword v27, v21, s[24:27], s66 offen sc1
NB16:
    s_endpgm
L_end:
.section .rodata,"a"
.p2align 6
.amdhsa_kernel gated_mix__sliding_local_dilated__swiglu_ffn__prompt_kernel
  .amdhsa_next_free_vgpr 512
  .amdhsa_next_free_sgpr 102
  .amdhsa_accum_offset 256
  .amdhsa_group_segment_fixed_size 0
  .amdhsa_kernarg_size 88
  .amdhsa_user_sgpr_count 2
  .amdhsa_user_sgpr_kernarg_segment_ptr 1
  .amdhsa_system_sgpr_workgroup_id_x 1
.end_amdhsa_kernel
```
